```python
import torch

def _softmax(x, axis=-1):
    return torch.softmax(x, dim=axis)
def _gelu(x):
    return torch.nn.functional.gelu(x, approximate="tanh")
def _silu(x):
    return torch.nn.functional.silu(x)
def _sigmoid(x):
    return torch.sigmoid(x)
def _layernorm(x, axis=-1, eps=1e-5):
    m = x.mean(dim=axis, keepdim=True)
    v = x.var(dim=axis, keepdim=True, unbiased=False)
    return (x - m) / torch.sqrt(v + eps)
def _scatter_add(tgt, idx, src, axis=0):
    return tgt.clone().index_add_(axis, idx, src)
def _segment_sum(src, seg, n):
    out = torch.zeros((n,) + src.shape[1:], dtype=src.dtype)
    return out.index_add_(0, seg, src)
def _pad(x, pw):
    flat = tuple(v for pair in reversed(pw) for v in pair)
    return torch.nn.functional.pad(x, flat)

kernel_name = 'gated_mix__spectral_gfnet__dense_activation_mish__prompt'

def setup_inputs():

    _w = (lambda a: (lambda t: t.to(torch.bfloat16) if t.is_floating_point() else t)(torch.as_tensor(a)))
    def _A_setup():
        B, S, D = 1, 2048, 512
        Df = D // 2 + 1
        return {
            "x": _w((lambda *s: torch.randn(*s, dtype=torch.bfloat16) * 0.05)(B, S, D)),
            "w_r": _w((lambda *s: torch.randn(*s, dtype=torch.bfloat16) * 0.8)(S, Df) * 0.02),
            "w_i": _w((lambda *s: torch.randn(*s, dtype=torch.bfloat16) * 0.8)(S, Df) * 0.02),
        }
    _A_in = _A_setup()

    def _B_setup():
        B, S, D, F = 1, 2048, 512, 1376
        return {
            "x": _w((lambda *s: torch.randn(*s, dtype=torch.bfloat16) * 0.05)(B, S, D)),
            "w1": _w((lambda *s: torch.randn(*s, dtype=torch.bfloat16) * 3.2)(D, F) * (D ** -0.5)),
            "b1": _w((lambda *s: torch.randn(*s, dtype=torch.bfloat16) * 0.05)(F)),
            "w2": _w((lambda *s: torch.randn(*s, dtype=torch.bfloat16) * 0.05)(F, D) * (F ** -0.5)),
        }
    _B_in = _B_setup()

    return {
        "A_x": _A_in["x"],
        "A_w_r": _A_in["w_r"],
        "A_w_i": _A_in["w_i"],
        "B_x": _B_in["x"],
        "B_w1": _B_in["w1"],
        "B_b1": _B_in["b1"],
        "B_w2": _B_in["w2"],
        "gate_w": _w((lambda *s: torch.randn(*s, dtype=torch.bfloat16) * 0.05)(512) * 16.0),
    }

def reference(A_x, A_w_r, A_w_i, B_x, B_w1, B_b1, B_w2, gate_w):
    def _A_ref(x, w_r, w_i):
        B, S, D = x.shape
        X = (lambda x, axes=(-2,-1): torch.fft.rfft2(x.float(), dim=axes))(x, axes=(-2, -1))
        W = w_r + 1j * w_i
        X = X * W
        y = (lambda x, s, axes=(-2,-1): torch.fft.irfft2(x, s=s, dim=axes).to(torch.bfloat16))(X, (S, D), axes=(-2, -1))
        return y

    def _B_ref(x, w1, b1, w2):
        h = torch.einsum("bsd,df->bsf", x, w1) + b1
        sp = torch.log1p(torch.exp(-torch.abs(h))) + torch.where(h > 0, h, torch.zeros_like(h))
        act = h * torch.tanh(sp)
        return torch.einsum("bsf,fd->bsd", act, w2)

    x = A_x
    g = _sigmoid((x * gate_w).sum(-1, keepdims=True))
    a = _A_ref(x, A_w_r, A_w_i)
    b = _B_ref(x, B_w1, B_b1, B_w2)
    return g * a + (1 - g) * b
```

```asm
; @launch grid=(256,1,1) block=(512,1,1) lds=158592
.amdgcn_target "amdgcn-amd-amdhsa--gfx950"
.text
.globl gated_mix__spectral_gfnet__dense_activation_mish__prompt_kernel
.p2align 8
.type gated_mix__spectral_gfnet__dense_activation_mish__prompt_kernel,@function
gated_mix__spectral_gfnet__dense_activation_mish__prompt_kernel:
    s_cmp_ge_u32 s2, 256
    s_cbranch_scc1 L_END
    s_load_dwordx16 s[4:19], s[0:1], 0
    s_load_dwordx2 s[20:21], s[0:1], 64
    s_load_dwordx2 s[22:23], s[0:1], 80
    v_lshrrev_b32 v2, 6, v0
    v_and_b32 v1, 63, v0
    s_getpc_b64 s[52:53]
L_PC:
    s_lshr_b32 s3, s2, 3
    s_and_b32 s3, s3, 7
    s_mul_i32 s3, s3, (L_END - L_PC + 63)/64/8 + 1
    v_add_u32 v6, s3, v0
    v_lshlrev_b32 v6, 6, v6
    v_min_u32 v6, L_END - L_PC, v6
    v_mov_b32 v9, s53
    v_add_co_u32 v8, vcc, s52, v6
    s_nop 1
    v_addc_co_u32 v9, vcc, 0, v9, vcc
    v_cmp_gt_u32 vcc, (L_END - L_PC + 63)/64/8 + 1, v0
    s_nop 0
    s_and_saveexec_b64 s[54:55], vcc
    s_cbranch_execz skip_1
    global_load_dword v255, v[8:9], off
skip_1:
    s_mov_b64 exec, s[54:55]
    v_readfirstlane_b32 s26, v2
    s_and_b32 s3, s2, 7
    s_lshl_b32 s24, s3, 2
    s_lshr_b32 s3, s2, 6
    s_add_u32 s24, s24, s3
    s_lshr_b32 s25, s2, 3
    s_and_b32 s25, s25, 7
    v_lshlrev_b32 v12, 4, v1
    s_and_b32 s27, s26, 3
    v_mov_b32 v4, 18176
    v_mov_b32 v5, 0
    v_and_b32_e64 v3, 31, v1
    v_lshl_add_u32 v3, v3, 2, v4
    ds_write_b32 v3, v5
    s_cmp_ge_u32 s26, 4
    s_cbranch_scc1 L_F
    s_setprio 1
    v_add_u32 v8, s27, v4
    v_mov_b32_e64 v9, 1
    s_and_b32 s53, s25, 1
    s_lshl_b32 s70, s53, 4
    s_add_u32 s70, s70, s27
    s_mul_i32 s71, s70, 2080
    s_lshl_b32 s70, s70, 16
    s_lshl_b32 s52, s24, 10
    s_add_u32 s70, s70, s52
    s_mov_b32 s30, 2097152
    s_mov_b32 s31, 0x20000
    s_waitcnt lgkmcnt(0)
    s_mov_b32 s28, s4
    s_mov_b32 s29, s5
    s_add_u32 m0, s71, 18304
    s_nop 0
    buffer_load_dwordx4 v12, s[28:31], s70 offen lds
    s_add_u32 m0, s71, 19344
    s_add_u32 s70, s70, 32768
    buffer_load_dwordx4 v12, s[28:31], s70 offen lds
    s_add_u32 m0, s71, 26624
    s_add_u32 s70, s70, 229376
    buffer_load_dwordx4 v12, s[28:31], s70 offen lds
    s_add_u32 m0, s71, 27664
    s_add_u32 s70, s70, 32768
    buffer_load_dwordx4 v12, s[28:31], s70 offen lds
    s_add_u32 m0, s71, 34944
    s_add_u32 s70, s70, 229376
    buffer_load_dwordx4 v12, s[28:31], s70 offen lds
    s_add_u32 m0, s71, 35984
    s_add_u32 s70, s70, 32768
    buffer_load_dwordx4 v12, s[28:31], s70 offen lds
    s_add_u32 m0, s71, 43264
    s_add_u32 s70, s70, 229376
    buffer_load_dwordx4 v12, s[28:31], s70 offen lds
    s_add_u32 m0, s71, 44304
    s_add_u32 s70, s70, 32768
    buffer_load_dwordx4 v12, s[28:31], s70 offen lds
    s_sub_u32 s70, s70, 819200
    s_xor_b32 s70, s70, 1048576
    s_mul_i32 s53, s53, 66560
    s_add_u32 s71, s71, 33280
    s_sub_u32 s71, s71, s53
    s_load_dwordx2 s[56:57], s[22:23], 0
    s_barrier
    s_mul_i32 s52, s24, 5
    s_add_u32 s52, s52, s25
    s_sub_u32 s52, s52, 8
    s_add_u32 s53, s24, 154
    s_cmp_eq_u32 s25, 2
    s_cselect_b32 s53, s53, 200
    s_cmp_ge_u32 s25, 3
    s_cselect_b32 s3, s52, s53
    s_cmp_eq_u32 s24, 0
    s_cselect_b32 s3, 200, s3
    s_and_b32 s52, s27, 1
    s_cmp_eq_u32 s52, 0
    s_cselect_b32 s48, s6, s8
    s_cselect_b32 s49, s7, s9
    s_sub_u32 s48, s48, 2048
    s_subb_u32 s49, s49, 0
    s_mov_b32 s50, 1054720
    s_mov_b32 s51, 0x20000
    s_cmp_ge_u32 s27, 2
    s_cselect_b64 vcc, -1, 0
    s_lshl_b32 s52, s25, 8
    s_add_u32 s52, s52, s24
    v_add_u32 v30, 0, v1
    v_mul_u32_u24 v31, 1986, v30
    v_lshrrev_b32 v31, 16, v31
    v_mul_u32_u24 v32, 33, v31
    v_sub_u32 v30, v30, v32
    v_lshlrev_b32 v30, 4, v30
    v_add_u32 v30, 2048, v30
    v_lshlrev_b32 v31, 6, v31
    v_add_u32_e64 v31, s52, v31
    v_sub_u32 v32, 2048, v31
    v_and_b32 v32, 2047, v32
    v_cndmask_b32 v32, v31, v32, vcc
    v_mul_u32_u24 v32, 514, v32
    v_and_b32 v32, -16, v32
    v_add_u32 v24, v32, v30
    v_add_u32 v33, 64, v1
    v_mul_u32_u24 v34, 1986, v33
    v_lshrrev_b32 v34, 16, v34
    v_mul_u32_u24 v35, 33, v34
    v_sub_u32 v33, v33, v35
    v_lshlrev_b32 v33, 4, v33
    v_add_u32 v33, 1024, v33
    v_lshlrev_b32 v34, 6, v34
    v_add_u32 v34, s52, v34
    v_sub_u32 v35, 2048, v34
    v_and_b32 v35, 2047, v35
    v_cndmask_b32 v35, v34, v35, vcc
    v_mul_u32_u24 v35, 514, v35
    v_and_b32 v35, -16, v35
    v_add_u32_e64 v25, v35, v33
    v_add_u32 v36, 128, v1
    v_mul_u32_u24 v37, 1986, v36
    v_lshrrev_b32 v37, 16, v37
    v_mul_u32_u24 v38, 33, v37
    v_sub_u32 v36, v36, v38
    v_lshlrev_b32 v36, 4, v36
    v_add_u32 v36, 0, v36
    v_lshlrev_b32 v37, 6, v37
    v_add_u32_e64 v37, s52, v37
    v_sub_u32 v38, 2048, v37
    v_and_b32 v38, 2047, v38
    v_cndmask_b32 v38, v37, v38, vcc
    v_mul_u32_u24 v38, 514, v38
    v_and_b32 v38, -16, v38
    v_add_u32_e64 v26, v38, v36
    s_mov_b32 s32, s12
    s_mov_b32 s33, s13
    s_mov_b32 s34, 1409024
    s_mov_b32 s35, 0x20000
    s_min_u32 s58, s25, 3
    s_mul_i32 s52, s25, 5
    s_add_u32 s58, s58, s52
    s_cmp_lt_u32 s25, 3
    s_cselect_b32 s59, 6, 5
    s_and_b32 s60, s27, 1
    s_lshr_b32 s61, s27, 1
    s_mul_i32 s54, s61, 3
    s_add_u32 s52, s58, s54
    s_lshl_b32 s52, s52, 6
    s_sub_u32 s55, s59, s54
    v_add_u32 v232, 0, v1
    v_mul_u32_u24 v233, 5462, v232
    v_lshrrev_b32 v233, 16, v233
    v_mul_u32_u24 v234, 12, v233
    v_sub_u32 v232, v232, v234
    v_lshrrev_b32 v234, 2, v232
    v_cmp_gt_u32_e64 vcc, s55, v234
    v_mul_u32_u24 v233, 2752, v233
    v_lshl_add_u32 v232, v232, 4, v233
    v_add_u32 v232, s52, v232
    v_mov_b32 v233, 1073741824
    v_cndmask_b32 v5, v233, v232, vcc
    v_add_u32 v232, 64, v1
    v_mul_u32_u24 v233, 5462, v232
    v_lshrrev_b32 v233, 16, v233
    v_mul_u32_u24 v234, 12, v233
    v_sub_u32 v232, v232, v234
    v_lshrrev_b32 v234, 2, v232
    v_cmp_gt_u32_e64 vcc, s55, v234
    v_mul_u32_u24 v233, 2752, v233
    v_lshl_add_u32 v232, v232, 4, v233
    v_add_u32 v232, s52, v232
    v_mov_b32 v233, 1073741824
    v_subrev_u32 v232, 1024, v232
    v_cndmask_b32_e64 v6, v233, v232, vcc
    v_add_u32 v232, 128, v1
    v_mul_u32_u24 v233, 5462, v232
    v_lshrrev_b32 v233, 16, v233
    v_mul_u32_u24 v234, 12, v233
    v_sub_u32 v232, v232, v234
    v_lshrrev_b32 v234, 2, v232
    v_cmp_gt_u32_e64 vcc, s55, v234
    v_mul_u32_u24 v233, 2752, v233
    v_lshl_add_u32 v232, v232, 4, v233
    v_add_u32 v232, s52, v232
    v_mov_b32 v233, 1073741824
    v_subrev_u32 v232, 2048, v232
    v_cndmask_b32_e64 v7, v233, v232, vcc
    s_mul_i32 s62, s60, 704512
    s_mul_i32 s73, s27, 18432
    v_and_b32 v232, 31, v1
    v_lshlrev_b32 v232, 1, v232
    v_cmp_gt_u32 vcc, 32, v1
    v_mov_b32 v233, 1073741824
    s_nop 0
    v_cndmask_b32 v23, v233, v232, vcc
    s_add_u32 s55, s54, 0
    s_cmp_lt_u32 s55, s59
    s_cselect_b32 s52, 0, 1073741824
    s_add_u32 s55, s55, s58
    s_lshl_b32 s63, s55, 12
    s_add_u32 s63, s63, s52
    s_lshl_b32 s55, s55, 6
    s_add_u32 s74, s55, s52
    s_add_u32 s55, s54, 1
    s_cmp_lt_u32 s55, s59
    s_cselect_b32 s52, 0, 1073741824
    s_add_u32 s55, s55, s58
    s_lshl_b32 s64, s55, 12
    s_add_u32 s64, s64, s52
    s_lshl_b32 s55, s55, 6
    s_add_u32 s75, s55, s52
    s_add_u32 s55, s54, 2
    s_cmp_lt_u32 s55, s59
    s_cselect_b32 s52, 0, 1073741824
    s_add_u32 s55, s55, s58
    s_lshl_b32 s65, s55, 12
    s_add_u32 s65, s65, s52
    s_lshl_b32 s55, s55, 6
    s_add_u32 s76, s55, s52
    s_mul_i32 s100, s24, 176128
    s_add_u32 s100, s100, 13631488
    s_add_u32 s40, s22, s100
    s_addc_u32 s41, s23, 0
    s_mov_b32 s42, 176128
    s_mov_b32 s43, 0x20000
    s_mul_i32 s100, s25, 176128
    s_add_u32 s100, s100, 11534336
    s_add_u32 s44, s22, s100
    s_addc_u32 s45, s23, 0
    s_mov_b32 s46, 176128
    s_mov_b32 s47, 0x20000
    s_lshl_b32 s100, s60, 10
    v_add_u32 v14, s100, v12
    v_and_b32 v233, 31, v1
    s_lshl_b32 s100, s61, 4
    v_xor_b32 v233, s100, v233
    s_add_u32 m0, s71, 18304
    s_nop 0
    buffer_load_dwordx4 v12, s[28:31], s70 offen lds
    v_lshrrev_b32 v234, 5, v1
    v_lshlrev_b32 v234, 9, v234
    v_lshl_add_u32 v3, v233, 4, v234
    s_lshl_b32 s78, s58, 1
    s_add_u32 s78, s78, s27
    s_lshl_b32 s78, s78, 11
    s_lshl_b32 s78, s27, 11
    s_add_u32 m0, s71, 19344
    s_add_u32 s70, s70, 32768
    buffer_load_dwordx4 v12, s[28:31], s70 offen lds
    s_lshl_b32 s100, s59, 1
    s_sub_u32 s100, s100, s27
    s_cmp_gt_u32 s100, 8
    s_cselect_b32 s79, 1, 0
    v_lshrrev_b32 v232, 5, v1
    v_lshlrev_b32 v232, 3, v232
    v_bfe_u32 v233, v1, 2, 2
    v_add_u32_e64 v232, v232, v233
    v_mul_u32_u24 v232, 192, v232
    s_add_u32 m0, s71, 26624
    s_add_u32 s70, s70, 229376
    buffer_load_dwordx4 v12, s[28:31], s70 offen lds
    v_bfe_u32 v234, v1, 4, 1
    v_lshl_add_u32 v232, v234, 5, v232
    v_and_b32_e64 v234, 3, v1
    v_lshl_add_u32 v232, v234, 3, v232
    s_add_u32 s100, s73, 84864
    v_add_u32_e64 v10, s100, v232
    s_add_u32 m0, s71, 27664
    s_add_u32 s70, s70, 32768
    buffer_load_dwordx4 v12, s[28:31], s70 offen lds
    v_add_u32 v13, s100, v12
    s_xor_b32 s100, s27, 1
    s_mul_i32 s100, s100, 18432
    s_add_u32 s100, s100, 84864
    v_add_u32 v15, s100, v12
    v_and_b32 v232, 31, v1
    v_mul_u32_u24 v232, 1040, v232
    v_lshrrev_b32_e64 v233, 5, v1
    v_lshl_add_u32 v232, v233, 4, v232
    s_add_u32 m0, s71, 34944
    s_add_u32 s70, s70, 229376
    buffer_load_dwordx4 v12, s[28:31], s70 offen lds
    s_mul_i32 s100, s60, 33792
    v_add_u32_e64 v11, s100, v232
    s_mul_i32 s100, s60, -32768
    s_add_u32 s100, s100, 33280
    v_add_u32 v2, s100, v232
    v_mov_b32 v57, 0
    v_mov_b32 v58, 0
    v_mov_b32 v59, 0
    s_add_u32 m0, s71, 35984
    s_add_u32 s70, s70, 32768
    buffer_load_dwordx4 v12, s[28:31], s70 offen lds
    v_mov_b32 v61, 0
    v_mov_b32 v62, 0
    v_mov_b32 v63, 0
    v_mov_b32 v65, 0
    v_mov_b32 v66, 0
    v_mov_b32 v67, 0
    v_cmp_gt_u32 vcc, 32, v1
    v_mov_b32 v232, 0x3f80
    v_mov_b32 v69, 0
    v_mov_b32 v70, 0
    v_mov_b32 v71, 0
    v_cndmask_b32 v68, 0, v232, vcc
    s_add_u32 m0, s71, 43264
    s_add_u32 s70, s70, 229376
    buffer_load_dwordx4 v12, s[28:31], s70 offen lds
    s_mov_b32 s66, 0xbfb8aa3b
    s_mov_b32 s67, 0xbfb8aa3b
    s_mov_b32 s68, 0.5
    s_mov_b32 s69, 0.5
    s_waitcnt lgkmcnt(0)
    s_mul_i32 s56, s56, 0x9e3779b1
    s_add_u32 s56, s56, 0x7f4a7c15
    s_mul_i32 s57, s57, 0x85ebca6b
    s_add_u32 s57, s57, 0xc2b2ae35
    s_add_u32 m0, s71, 44304
    s_add_u32 s70, s70, 32768
    buffer_load_dwordx4 v12, s[28:31], s70 offen lds
    s_mov_b32 s36, s14
    s_mov_b32 s37, s15
    s_mov_b32 s38, 2752
    s_mov_b32 s39, 0x20000
    buffer_load_ushort v56, v23, s[36:39], s74 offen
    buffer_load_ushort v60, v23, s[36:39], s75 offen
    buffer_load_ushort v64, v23, s[36:39], s76 offen
    s_mul_i32 s53, s27, 2112
    s_add_u32 m0, s53, 0
    s_nop 0
    buffer_load_dwordx4 v24, s[48:51], 0 offen offset:0 lds
    buffer_load_dwordx4 v25, s[48:51], 0 offen offset:1024 lds
    s_mov_b64 exec, 15
    buffer_load_dwordx4 v26, s[48:51], 0 offen offset:2048 lds
    s_mov_b64 exec, -1
    s_cmp_lg_u32 s24, 0
    s_cbranch_scc1 skip_2
    s_cmp_ge_u32 s27, 2
    s_cselect_b64 vcc, -1, 0
    v_add_u32_e64 v31, 32, v31
    v_sub_u32 v32, 2048, v31
    v_and_b32 v32, 2047, v32
    v_cndmask_b32 v32, v31, v32, vcc
    v_mul_u32_u24 v32, 514, v32
    v_and_b32 v32, -16, v32
    v_add_u32 v27, v32, v30
    v_add_u32 v34, 32, v34
    v_sub_u32 v35, 2048, v34
    v_and_b32 v35, 2047, v35
    v_cndmask_b32 v35, v34, v35, vcc
    v_mul_u32_u24 v35, 514, v35
    v_and_b32 v35, -16, v35
    v_add_u32 v28, v35, v33
    v_add_u32 v37, 32, v37
    v_sub_u32 v38, 2048, v37
    v_and_b32 v38, 2047, v38
    v_cndmask_b32 v38, v37, v38, vcc
    v_mul_u32_u24 v38, 514, v38
    v_and_b32 v38, -16, v38
    v_add_u32_e64 v29, v38, v36
    s_mul_i32 s53, s27, 2112
    s_add_u32 m0, s53, 8448
    s_nop 0
    buffer_load_dwordx4 v27, s[48:51], 0 offen offset:0 lds
    buffer_load_dwordx4 v28, s[48:51], 0 offen offset:1024 lds
    s_mov_b64 exec, 15
    buffer_load_dwordx4 v29, s[48:51], 0 offen offset:2048 lds
    s_mov_b64 exec, -1
skip_2:
    s_lshr_b32 s52, s3, 1
    s_lshl_b32 s52, s52, 14
    s_and_b32 s53, s3, 1
    s_lshl_b32 s53, s53, 12
    s_add_u32 s52, s52, s53
    s_lshr_b32 s53, s27, 1
    s_lshl_b32 s53, s53, 13
    s_add_u32 s52, s52, s53
    s_and_b32 s53, s27, 1
    s_lshl_b32 s53, s53, 11
    s_add_u32 s52, s52, s53
    s_mov_b32 s36, s16
    s_mov_b32 s37, s17
    s_mov_b32 s38, 1409024
    s_mov_b32 s39, 0x20000
    s_lshl_b32 s53, s27, 11
    s_add_u32 m0, s53, 8704
    s_cmp_ge_u32 s3, 172
    s_cbranch_scc1 skip_3
    buffer_load_dwordx4 v12, s[36:39], s52 offen offset:0 lds
    buffer_load_dwordx4 v12, s[36:39], s52 offen offset:1024 lds
skip_3:
    s_mov_b32 s36, s18
    s_mov_b32 s37, s19
    s_mov_b32 s38, 1024
    s_mov_b32 s39, 0x20000
    s_lshl_b32 s52, s27, 8
    s_add_u32 m0, s52, 16896
    v_lshlrev_b32 v39, 2, v1
    buffer_load_dword v39, s[36:39], s52 offen lds
    s_mov_b32 s48, s20
    s_mov_b32 s49, s21
    s_mov_b32 s50, 2097152
    s_mov_b32 s51, 0x20000
    s_add_u32 m0, s73, 84864
    s_nop 0
    buffer_load_dwordx4 v5, s[32:35], s62 offen offset:0 lds
    buffer_load_dwordx4 v6, s[32:35], s62 offen offset:1024 lds
    buffer_load_dwordx4 v7, s[32:35], s62 offen offset:2048 lds
    s_waitcnt vmcnt(10)
    ds_write_b8 v8, v9 offset:0
    s_add_u32 m0, s73, 87936
    s_add_u32 s62, s62, 44032
    buffer_load_dwordx4 v5, s[32:35], s62 offen offset:0 lds
    buffer_load_dwordx4 v6, s[32:35], s62 offen offset:1024 lds
    buffer_load_dwordx4 v7, s[32:35], s62 offen offset:2048 lds
    s_add_u32 m0, s73, 91008
    s_add_u32 s62, s62, 44032
    buffer_load_dwordx4 v5, s[32:35], s62 offen offset:0 lds
    buffer_load_dwordx4 v6, s[32:35], s62 offen offset:1024 lds
    buffer_load_dwordx4 v7, s[32:35], s62 offen offset:2048 lds
    s_add_u32 m0, s73, 94080
    s_add_u32 s62, s62, 44032
    buffer_load_dwordx4 v5, s[32:35], s62 offen offset:0 lds
    buffer_load_dwordx4 v6, s[32:35], s62 offen offset:1024 lds
    buffer_load_dwordx4 v7, s[32:35], s62 offen offset:2048 lds
    s_waitcnt vmcnt(18)
    s_nop 0
    v_mfma_f32_32x32x16_bf16 v[136:151], v[56:59], v[68:71], 0
    s_waitcnt vmcnt(17)
    v_mfma_f32_32x32x16_bf16 v[152:167], v[60:63], v[68:71], 0
    s_waitcnt vmcnt(16)
    v_mfma_f32_32x32x16_bf16 v[168:183], v[64:67], v[68:71], 0
    s_waitcnt vmcnt(9)
    ds_write_b8 v8, v9 offset:16
    s_waitcnt lgkmcnt(0)
spin4_4:
    ds_read_b32 v232, v4 offset:0
    s_waitcnt lgkmcnt(0)
    v_cmp_ne_u32 vcc, 16843009, v232
    s_cbranch_vccnz spin4_4
    ds_read_b128 v[16:19], v11 offset:18304
    ds_read_b128 v[20:23], v2 offset:18304
    ds_read_b64_tr_b16 v[24:25], v10 offset:0
    ds_read_b64_tr_b16 v[26:27], v10 offset:768
    ds_read_b64_tr_b16 v[28:29], v10 offset:64
    ds_read_b64_tr_b16 v[30:31], v10 offset:832
    ds_read_b64_tr_b16 v[32:33], v10 offset:128
    ds_read_b64_tr_b16 v[34:35], v10 offset:896
    s_add_u32 m0, s73, 97152
    s_add_u32 s62, s62, 44032
    buffer_load_dwordx4 v5, s[32:35], s62 offen offset:0 lds
    buffer_load_dwordx4 v6, s[32:35], s62 offen offset:1024 lds
    buffer_load_dwordx4 v7, s[32:35], s62 offen offset:2048 lds
    s_waitcnt lgkmcnt(0)
    v_mfma_f32_32x32x16_bf16 v[136:151], v[24:27], v[16:19], v[136:151]
    s_waitcnt vmcnt(9)
    ds_read_b128 v[36:39], v11 offset:18336
    ds_read_b128 v[40:43], v2 offset:18336
    s_add_u32 m0, s73, 100224
    s_add_u32 s62, s62, 44032
    buffer_load_dwordx4 v5, s[32:35], s62 offen offset:0 lds
    v_mfma_f32_32x32x16_bf16 v[184:199], v[24:27], v[20:23], 0
    ds_read_b64_tr_b16 v[44:45], v10 offset:3072
    ds_read_b64_tr_b16 v[46:47], v10 offset:3840
    buffer_load_dwordx4 v6, s[32:35], s62 offen offset:1024 lds
    v_mfma_f32_32x32x16_bf16 v[152:167], v[28:31], v[16:19], v[152:167]
    ds_read_b64_tr_b16 v[48:49], v10 offset:3136
    ds_read_b64_tr_b16 v[50:51], v10 offset:3904
    buffer_load_dwordx4 v7, s[32:35], s62 offen offset:2048 lds
    v_mfma_f32_32x32x16_bf16 v[200:215], v[28:31], v[20:23], 0
    ds_read_b64_tr_b16 v[52:53], v10 offset:3200
    ds_read_b64_tr_b16 v[54:55], v10 offset:3968
    s_add_u32 m0, s73, 84864
    s_add_u32 s62, s62, 44032
    buffer_load_dwordx4 v5, s[32:35], s62 offen offset:0 lds
    v_mfma_f32_32x32x16_bf16 v[168:183], v[32:35], v[16:19], v[168:183]
    buffer_load_dwordx4 v6, s[32:35], s62 offen offset:1024 lds
    v_mfma_f32_32x32x16_bf16 v[216:231], v[32:35], v[20:23], 0
    buffer_load_dwordx4 v7, s[32:35], s62 offen offset:2048 lds
    s_waitcnt lgkmcnt(0)
    v_mfma_f32_32x32x16_bf16 v[136:151], v[44:47], v[36:39], v[136:151]
    s_waitcnt vmcnt(12)
    ds_read_b128 v[16:19], v11 offset:18368
    ds_read_b128 v[20:23], v2 offset:18368
    v_mfma_f32_32x32x16_bf16 v[184:199], v[44:47], v[40:43], v[184:199]
    ds_read_b64_tr_b16 v[24:25], v10 offset:6144
    ds_read_b64_tr_b16 v[26:27], v10 offset:6912
    s_add_u32 m0, s73, 87936
    v_mfma_f32_32x32x16_bf16 v[152:167], v[48:51], v[36:39], v[152:167]
    ds_read_b64_tr_b16 v[28:29], v10 offset:6208
    ds_read_b64_tr_b16 v[30:31], v10 offset:6976
    s_add_u32 s62, s62, 44032
    v_mfma_f32_32x32x16_bf16 v[200:215], v[48:51], v[40:43], v[200:215]
    ds_read_b64_tr_b16 v[32:33], v10 offset:6272
    ds_read_b64_tr_b16 v[34:35], v10 offset:7040
    buffer_load_dwordx4 v5, s[32:35], s62 offen offset:0 lds
    v_mfma_f32_32x32x16_bf16 v[168:183], v[52:55], v[36:39], v[168:183]
    buffer_load_dwordx4 v6, s[32:35], s62 offen offset:1024 lds
    v_mfma_f32_32x32x16_bf16 v[216:231], v[52:55], v[40:43], v[216:231]
    buffer_load_dwordx4 v7, s[32:35], s62 offen offset:2048 lds
    s_waitcnt lgkmcnt(0)
    v_mfma_f32_32x32x16_bf16 v[136:151], v[24:27], v[16:19], v[136:151]
    s_waitcnt vmcnt(12)
    ds_read_b128 v[36:39], v11 offset:18400
    ds_read_b128 v[40:43], v2 offset:18400
    v_mfma_f32_32x32x16_bf16 v[184:199], v[24:27], v[20:23], v[184:199]
    ds_read_b64_tr_b16 v[44:45], v10 offset:9216
    ds_read_b64_tr_b16 v[46:47], v10 offset:9984
    s_add_u32 m0, s73, 91008
    v_mfma_f32_32x32x16_bf16 v[152:167], v[28:31], v[16:19], v[152:167]
    ds_read_b64_tr_b16 v[48:49], v10 offset:9280
    ds_read_b64_tr_b16 v[50:51], v10 offset:10048
    s_add_u32 s62, s62, 44032
    v_mfma_f32_32x32x16_bf16 v[200:215], v[28:31], v[20:23], v[200:215]
    ds_read_b64_tr_b16 v[52:53], v10 offset:9344
    ds_read_b64_tr_b16 v[54:55], v10 offset:10112
    buffer_load_dwordx4 v5, s[32:35], s62 offen offset:0 lds
    v_mfma_f32_32x32x16_bf16 v[168:183], v[32:35], v[16:19], v[168:183]
    buffer_load_dwordx4 v6, s[32:35], s62 offen offset:1024 lds
    v_mfma_f32_32x32x16_bf16 v[216:231], v[32:35], v[20:23], v[216:231]
    buffer_load_dwordx4 v7, s[32:35], s62 offen offset:2048 lds
    s_waitcnt lgkmcnt(0)
    v_mfma_f32_32x32x16_bf16 v[136:151], v[44:47], v[36:39], v[136:151]
    s_waitcnt vmcnt(12)
    ds_read_b128 v[16:19], v11 offset:18432
    ds_read_b128 v[20:23], v2 offset:18432
    v_mfma_f32_32x32x16_bf16 v[184:199], v[44:47], v[40:43], v[184:199]
    ds_read_b64_tr_b16 v[24:25], v10 offset:12288
    ds_read_b64_tr_b16 v[26:27], v10 offset:13056
    s_add_u32 m0, s73, 94080
    v_mfma_f32_32x32x16_bf16 v[152:167], v[48:51], v[36:39], v[152:167]
    ds_read_b64_tr_b16 v[28:29], v10 offset:12352
    ds_read_b64_tr_b16 v[30:31], v10 offset:13120
    s_add_u32 s62, s62, 44032
    v_mfma_f32_32x32x16_bf16 v[200:215], v[48:51], v[40:43], v[200:215]
    ds_read_b64_tr_b16 v[32:33], v10 offset:12416
    ds_read_b64_tr_b16 v[34:35], v10 offset:13184
    buffer_load_dwordx4 v5, s[32:35], s62 offen offset:0 lds
    v_mfma_f32_32x32x16_bf16 v[168:183], v[52:55], v[36:39], v[168:183]
    buffer_load_dwordx4 v6, s[32:35], s62 offen offset:1024 lds
    v_mfma_f32_32x32x16_bf16 v[216:231], v[52:55], v[40:43], v[216:231]
    buffer_load_dwordx4 v7, s[32:35], s62 offen offset:2048 lds
    s_waitcnt lgkmcnt(0)
    v_mfma_f32_32x32x16_bf16 v[136:151], v[24:27], v[16:19], v[136:151]
    s_waitcnt vmcnt(12)
    ds_read_b128 v[36:39], v11 offset:18464
    ds_read_b128 v[40:43], v2 offset:18464
    v_mfma_f32_32x32x16_bf16 v[184:199], v[24:27], v[20:23], v[184:199]
    ds_read_b64_tr_b16 v[44:45], v10 offset:15360
    ds_read_b64_tr_b16 v[46:47], v10 offset:16128
    s_add_u32 m0, s73, 97152
    v_mfma_f32_32x32x16_bf16 v[152:167], v[28:31], v[16:19], v[152:167]
    ds_read_b64_tr_b16 v[48:49], v10 offset:15424
    ds_read_b64_tr_b16 v[50:51], v10 offset:16192
    s_add_u32 s62, s62, 44032
    v_mfma_f32_32x32x16_bf16 v[200:215], v[28:31], v[20:23], v[200:215]
    ds_read_b64_tr_b16 v[52:53], v10 offset:15488
    ds_read_b64_tr_b16 v[54:55], v10 offset:16256
    buffer_load_dwordx4 v5, s[32:35], s62 offen offset:0 lds
    v_mfma_f32_32x32x16_bf16 v[168:183], v[32:35], v[16:19], v[168:183]
    buffer_load_dwordx4 v6, s[32:35], s62 offen offset:1024 lds
    v_mfma_f32_32x32x16_bf16 v[216:231], v[32:35], v[20:23], v[216:231]
    buffer_load_dwordx4 v7, s[32:35], s62 offen offset:2048 lds
    s_waitcnt lgkmcnt(0)
    v_mfma_f32_32x32x16_bf16 v[136:151], v[44:47], v[36:39], v[136:151]
    s_waitcnt vmcnt(12)
    ds_read_b128 v[16:19], v11 offset:18496
    ds_read_b128 v[20:23], v2 offset:18496
    v_mfma_f32_32x32x16_bf16 v[184:199], v[44:47], v[40:43], v[184:199]
    ds_read_b64_tr_b16 v[24:25], v10 offset:0
    ds_read_b64_tr_b16 v[26:27], v10 offset:768
    s_add_u32 m0, s73, 100224
    v_mfma_f32_32x32x16_bf16 v[152:167], v[48:51], v[36:39], v[152:167]
    ds_read_b64_tr_b16 v[28:29], v10 offset:64
    ds_read_b64_tr_b16 v[30:31], v10 offset:832
    s_add_u32 s62, s62, 44032
    v_mfma_f32_32x32x16_bf16 v[200:215], v[48:51], v[40:43], v[200:215]
    ds_read_b64_tr_b16 v[32:33], v10 offset:128
    ds_read_b64_tr_b16 v[34:35], v10 offset:896
    buffer_load_dwordx4 v5, s[32:35], s62 offen offset:0 lds
    v_mfma_f32_32x32x16_bf16 v[168:183], v[52:55], v[36:39], v[168:183]
    buffer_load_dwordx4 v6, s[32:35], s62 offen offset:1024 lds
    v_mfma_f32_32x32x16_bf16 v[216:231], v[52:55], v[40:43], v[216:231]
    buffer_load_dwordx4 v7, s[32:35], s62 offen offset:2048 lds
    s_waitcnt lgkmcnt(0)
    v_mfma_f32_32x32x16_bf16 v[136:151], v[24:27], v[16:19], v[136:151]
    s_waitcnt vmcnt(12)
    ds_read_b128 v[36:39], v11 offset:18528
    ds_read_b128 v[40:43], v2 offset:18528
    v_mfma_f32_32x32x16_bf16 v[184:199], v[24:27], v[20:23], v[184:199]
    ds_read_b64_tr_b16 v[44:45], v10 offset:3072
    ds_read_b64_tr_b16 v[46:47], v10 offset:3840
    s_add_u32 m0, s73, 84864
    v_mfma_f32_32x32x16_bf16 v[152:167], v[28:31], v[16:19], v[152:167]
    ds_read_b64_tr_b16 v[48:49], v10 offset:3136
    ds_read_b64_tr_b16 v[50:51], v10 offset:3904
    s_add_u32 s62, s62, 44032
    v_mfma_f32_32x32x16_bf16 v[200:215], v[28:31], v[20:23], v[200:215]
    ds_read_b64_tr_b16 v[52:53], v10 offset:3200
    ds_read_b64_tr_b16 v[54:55], v10 offset:3968
    buffer_load_dwordx4 v5, s[32:35], s62 offen offset:0 lds
    v_mfma_f32_32x32x16_bf16 v[168:183], v[32:35], v[16:19], v[168:183]
    buffer_load_dwordx4 v6, s[32:35], s62 offen offset:1024 lds
    v_mfma_f32_32x32x16_bf16 v[216:231], v[32:35], v[20:23], v[216:231]
    buffer_load_dwordx4 v7, s[32:35], s62 offen offset:2048 lds
    s_waitcnt lgkmcnt(0)
    v_mfma_f32_32x32x16_bf16 v[136:151], v[44:47], v[36:39], v[136:151]
    s_waitcnt vmcnt(12)
    ds_read_b128 v[16:19], v11 offset:18560
    ds_read_b128 v[20:23], v2 offset:18560
    v_mfma_f32_32x32x16_bf16 v[184:199], v[44:47], v[40:43], v[184:199]
    ds_read_b64_tr_b16 v[24:25], v10 offset:6144
    ds_read_b64_tr_b16 v[26:27], v10 offset:6912
    s_add_u32 m0, s73, 87936
    v_mfma_f32_32x32x16_bf16 v[152:167], v[48:51], v[36:39], v[152:167]
    ds_read_b64_tr_b16 v[28:29], v10 offset:6208
    ds_read_b64_tr_b16 v[30:31], v10 offset:6976
    s_add_u32 s62, s62, 44032
    v_mfma_f32_32x32x16_bf16 v[200:215], v[48:51], v[40:43], v[200:215]
    ds_read_b64_tr_b16 v[32:33], v10 offset:6272
    ds_read_b64_tr_b16 v[34:35], v10 offset:7040
    buffer_load_dwordx4 v5, s[32:35], s62 offen offset:0 lds
    v_mfma_f32_32x32x16_bf16 v[168:183], v[52:55], v[36:39], v[168:183]
    buffer_load_dwordx4 v6, s[32:35], s62 offen offset:1024 lds
    v_mfma_f32_32x32x16_bf16 v[216:231], v[52:55], v[40:43], v[216:231]
    buffer_load_dwordx4 v7, s[32:35], s62 offen offset:2048 lds
    s_waitcnt lgkmcnt(0)
    v_mfma_f32_32x32x16_bf16 v[136:151], v[24:27], v[16:19], v[136:151]
    s_waitcnt vmcnt(12)
    ds_read_b128 v[36:39], v11 offset:18592
    ds_read_b128 v[40:43], v2 offset:18592
    v_mfma_f32_32x32x16_bf16 v[184:199], v[24:27], v[20:23], v[184:199]
    ds_read_b64_tr_b16 v[44:45], v10 offset:9216
    ds_read_b64_tr_b16 v[46:47], v10 offset:9984
    s_add_u32 m0, s73, 91008
    v_mfma_f32_32x32x16_bf16 v[152:167], v[28:31], v[16:19], v[152:167]
    ds_read_b64_tr_b16 v[48:49], v10 offset:9280
    ds_read_b64_tr_b16 v[50:51], v10 offset:10048
    s_add_u32 s62, s62, 44032
    v_mfma_f32_32x32x16_bf16 v[200:215], v[28:31], v[20:23], v[200:215]
    ds_read_b64_tr_b16 v[52:53], v10 offset:9344
    ds_read_b64_tr_b16 v[54:55], v10 offset:10112
    buffer_load_dwordx4 v5, s[32:35], s62 offen offset:0 lds
    v_mfma_f32_32x32x16_bf16 v[168:183], v[32:35], v[16:19], v[168:183]
    buffer_load_dwordx4 v6, s[32:35], s62 offen offset:1024 lds
    v_mfma_f32_32x32x16_bf16 v[216:231], v[32:35], v[20:23], v[216:231]
    buffer_load_dwordx4 v7, s[32:35], s62 offen offset:2048 lds
    s_waitcnt lgkmcnt(0)
    v_mfma_f32_32x32x16_bf16 v[136:151], v[44:47], v[36:39], v[136:151]
    s_waitcnt vmcnt(12)
    ds_read_b128 v[16:19], v11 offset:18624
    ds_read_b128 v[20:23], v2 offset:18624
    v_mfma_f32_32x32x16_bf16 v[184:199], v[44:47], v[40:43], v[184:199]
    ds_read_b64_tr_b16 v[24:25], v10 offset:12288
    ds_read_b64_tr_b16 v[26:27], v10 offset:13056
    s_add_u32 m0, s73, 94080
    v_mfma_f32_32x32x16_bf16 v[152:167], v[48:51], v[36:39], v[152:167]
    ds_read_b64_tr_b16 v[28:29], v10 offset:12352
    ds_read_b64_tr_b16 v[30:31], v10 offset:13120
    s_add_u32 s62, s62, 44032
    v_mfma_f32_32x32x16_bf16 v[200:215], v[48:51], v[40:43], v[200:215]
    ds_read_b64_tr_b16 v[32:33], v10 offset:12416
    ds_read_b64_tr_b16 v[34:35], v10 offset:13184
    buffer_load_dwordx4 v5, s[32:35], s62 offen offset:0 lds
    v_mfma_f32_32x32x16_bf16 v[168:183], v[52:55], v[36:39], v[168:183]
    buffer_load_dwordx4 v6, s[32:35], s62 offen offset:1024 lds
    v_mfma_f32_32x32x16_bf16 v[216:231], v[52:55], v[40:43], v[216:231]
    buffer_load_dwordx4 v7, s[32:35], s62 offen offset:2048 lds
    s_waitcnt lgkmcnt(0)
    v_mfma_f32_32x32x16_bf16 v[136:151], v[24:27], v[16:19], v[136:151]
    s_waitcnt vmcnt(12)
    ds_read_b128 v[36:39], v11 offset:18656
    ds_read_b128 v[40:43], v2 offset:18656
    v_mfma_f32_32x32x16_bf16 v[184:199], v[24:27], v[20:23], v[184:199]
    ds_read_b64_tr_b16 v[44:45], v10 offset:15360
    ds_read_b64_tr_b16 v[46:47], v10 offset:16128
    v_mfma_f32_32x32x16_bf16 v[152:167], v[28:31], v[16:19], v[152:167]
    ds_read_b64_tr_b16 v[48:49], v10 offset:15424
    ds_read_b64_tr_b16 v[50:51], v10 offset:16192
    v_mfma_f32_32x32x16_bf16 v[200:215], v[28:31], v[20:23], v[200:215]
    ds_read_b64_tr_b16 v[52:53], v10 offset:15488
    ds_read_b64_tr_b16 v[54:55], v10 offset:16256
    v_mfma_f32_32x32x16_bf16 v[168:183], v[32:35], v[16:19], v[168:183]
    v_mfma_f32_32x32x16_bf16 v[216:231], v[32:35], v[20:23], v[216:231]
    s_waitcnt lgkmcnt(0)
    v_mfma_f32_32x32x16_bf16 v[136:151], v[44:47], v[36:39], v[136:151]
    s_waitcnt vmcnt(9)
    ds_read_b128 v[16:19], v11 offset:18688
    ds_read_b128 v[20:23], v2 offset:18688
    v_mfma_f32_32x32x16_bf16 v[184:199], v[44:47], v[40:43], v[184:199]
    ds_read_b64_tr_b16 v[24:25], v10 offset:0
    ds_read_b64_tr_b16 v[26:27], v10 offset:768
    v_mfma_f32_32x32x16_bf16 v[152:167], v[48:51], v[36:39], v[152:167]
    ds_read_b64_tr_b16 v[28:29], v10 offset:64
    ds_read_b64_tr_b16 v[30:31], v10 offset:832
    v_mfma_f32_32x32x16_bf16 v[200:215], v[48:51], v[40:43], v[200:215]
    ds_read_b64_tr_b16 v[32:33], v10 offset:128
    ds_read_b64_tr_b16 v[34:35], v10 offset:896
    v_mfma_f32_32x32x16_bf16 v[168:183], v[52:55], v[36:39], v[168:183]
    v_mfma_f32_32x32x16_bf16 v[216:231], v[52:55], v[40:43], v[216:231]
    s_waitcnt lgkmcnt(0)
    v_mfma_f32_32x32x16_bf16 v[136:151], v[24:27], v[16:19], v[136:151]
    s_waitcnt vmcnt(6)
    ds_read_b128 v[36:39], v11 offset:18720
    ds_read_b128 v[40:43], v2 offset:18720
    v_mfma_f32_32x32x16_bf16 v[184:199], v[24:27], v[20:23], v[184:199]
    ds_read_b64_tr_b16 v[44:45], v10 offset:3072
    ds_read_b64_tr_b16 v[46:47], v10 offset:3840
    v_mfma_f32_32x32x16_bf16 v[152:167], v[28:31], v[16:19], v[152:167]
    ds_read_b64_tr_b16 v[48:49], v10 offset:3136
    ds_read_b64_tr_b16 v[50:51], v10 offset:3904
    v_mfma_f32_32x32x16_bf16 v[200:215], v[28:31], v[20:23], v[200:215]
    ds_read_b64_tr_b16 v[52:53], v10 offset:3200
    ds_read_b64_tr_b16 v[54:55], v10 offset:3968
    v_mfma_f32_32x32x16_bf16 v[168:183], v[32:35], v[16:19], v[168:183]
    v_mfma_f32_32x32x16_bf16 v[216:231], v[32:35], v[20:23], v[216:231]
    ds_write_b8 v8, v9 offset:28
    s_waitcnt lgkmcnt(1)
    v_mfma_f32_32x32x16_bf16 v[136:151], v[44:47], v[36:39], v[136:151]
    s_waitcnt vmcnt(3)
    ds_read_b128 v[16:19], v11 offset:18752
    ds_read_b128 v[20:23], v2 offset:18752
    v_mfma_f32_32x32x16_bf16 v[184:199], v[44:47], v[40:43], v[184:199]
    ds_read_b64_tr_b16 v[24:25], v10 offset:6144
    ds_read_b64_tr_b16 v[26:27], v10 offset:6912
    v_mfma_f32_32x32x16_bf16 v[152:167], v[48:51], v[36:39], v[152:167]
    ds_read_b64_tr_b16 v[28:29], v10 offset:6208
    ds_read_b64_tr_b16 v[30:31], v10 offset:6976
    v_mfma_f32_32x32x16_bf16 v[200:215], v[48:51], v[40:43], v[200:215]
    ds_read_b64_tr_b16 v[32:33], v10 offset:6272
    ds_read_b64_tr_b16 v[34:35], v10 offset:7040
    v_mfma_f32_32x32x16_bf16 v[168:183], v[52:55], v[36:39], v[168:183]
    v_mfma_f32_32x32x16_bf16 v[216:231], v[52:55], v[40:43], v[216:231]
    s_waitcnt lgkmcnt(0)
    v_mfma_f32_32x32x16_bf16 v[184:199], v[24:27], v[20:23], v[184:199]
    s_waitcnt vmcnt(0)
    ds_read_b128 v[36:39], v11 offset:18784
    ds_read_b128 v[40:43], v2 offset:18784
    ds_read_b64_tr_b16 v[44:45], v10 offset:9216
    ds_read_b64_tr_b16 v[46:47], v10 offset:9984
    v_mfma_f32_32x32x16_bf16 v[200:215], v[28:31], v[20:23], v[200:215]
    ds_read_b64_tr_b16 v[48:49], v10 offset:9280
    ds_read_b64_tr_b16 v[50:51], v10 offset:10048
    ds_read_b64_tr_b16 v[52:53], v10 offset:9344
    ds_read_b64_tr_b16 v[54:55], v10 offset:10112
    v_mfma_f32_32x32x16_bf16 v[216:231], v[32:35], v[20:23], v[216:231]
    v_mfma_f32_32x32x16_bf16 v[136:151], v[24:27], v[16:19], v[136:151]
    s_waitcnt lgkmcnt(0)
    v_mfma_f32_32x32x16_bf16 v[184:199], v[44:47], v[40:43], v[184:199]
    v_mfma_f32_32x32x16_bf16 v[200:215], v[48:51], v[40:43], v[200:215]
    v_mfma_f32_32x32x16_bf16 v[216:231], v[52:55], v[40:43], v[216:231]
    v_mfma_f32_32x32x16_bf16 v[152:167], v[28:31], v[16:19], v[152:167]
    v_mfma_f32_32x32x16_bf16 v[168:183], v[32:35], v[16:19], v[168:183]
    s_nop 7
    ds_write_b128 v13, v[184:187] offset:0
    ds_write_b128 v13, v[188:191] offset:1024
    ds_write_b128 v13, v[192:195] offset:2048
    ds_write_b128 v13, v[196:199] offset:3072
    v_mfma_f32_32x32x16_bf16 v[136:151], v[44:47], v[36:39], v[136:151]
    ds_write_b128 v13, v[200:203] offset:4096
    ds_write_b128 v13, v[204:207] offset:5120
    ds_write_b128 v13, v[208:211] offset:6144
    v_mfma_f32_32x32x16_bf16 v[152:167], v[48:51], v[36:39], v[152:167]
    ds_write_b128 v13, v[212:215] offset:7168
    ds_write_b128 v13, v[216:219] offset:8192
    ds_write_b128 v13, v[220:223] offset:9216
    v_mfma_f32_32x32x16_bf16 v[168:183], v[52:55], v[36:39], v[168:183]
    s_setprio 3
    s_nop 0
    ds_write_b128 v13, v[224:227] offset:10240
    ds_write_b128 v13, v[228:231] offset:11264
    s_waitcnt lgkmcnt(0)
    ds_write_b8 v8, v9 offset:8
    s_waitcnt lgkmcnt(0)
spin4_5:
    ds_read_b32 v232, v4 offset:8
    s_waitcnt lgkmcnt(0)
    v_cmp_ne_u32 vcc, 16843009, v232
    s_cbranch_vccnz spin4_5
    ds_read_b128 v[184:187], v15 offset:0
    ds_read_b128 v[188:191], v15 offset:1024
    ds_read_b128 v[192:195], v15 offset:2048
    ds_read_b128 v[196:199], v15 offset:3072
    ds_read_b128 v[200:203], v15 offset:4096
    ds_read_b128 v[204:207], v15 offset:5120
    ds_read_b128 v[208:211], v15 offset:6144
    ds_read_b128 v[212:215], v15 offset:7168
    ds_read_b128 v[216:219], v15 offset:8192
    ds_read_b128 v[220:223], v15 offset:9216
    ds_read_b128 v[224:227], v15 offset:10240
    ds_read_b128 v[228:231], v15 offset:11264
    s_waitcnt lgkmcnt(11)
    v_pk_add_f32 v[136:137], v[136:137], v[184:185]
    v_pk_add_f32 v[138:139], v[138:139], v[186:187]
    s_waitcnt lgkmcnt(10)
    v_pk_add_f32 v[140:141], v[140:141], v[188:189]
    v_pk_add_f32 v[142:143], v[142:143], v[190:191]
    v_pk_mul_f32 v[232:233], v[136:137], s[66:67]
    v_pk_mul_f32 v[234:235], v[138:139], s[66:67]
    v_pk_mul_f32 v[236:237], v[140:141], s[66:67]
    v_pk_mul_f32 v[238:239], v[142:143], s[66:67]
    v_exp_f32 v232, v232
    v_exp_f32 v233, v233
    v_exp_f32 v234, v234
    v_exp_f32 v235, v235
    v_exp_f32 v236, v236
    v_exp_f32 v237, v237
    v_exp_f32 v238, v238
    v_exp_f32 v239, v239
    v_pk_add_f32 v[240:241], v[232:233], s[68:69]
    v_pk_add_f32 v[242:243], v[234:235], s[68:69]
    v_pk_add_f32 v[244:245], v[236:237], s[68:69]
    v_pk_add_f32 v[246:247], v[238:239], s[68:69]
    v_pk_fma_f32 v[232:233], v[232:233], v[232:233], v[240:241]
    v_pk_fma_f32 v[234:235], v[234:235], v[234:235], v[242:243]
    v_pk_fma_f32 v[236:237], v[236:237], v[236:237], v[244:245]
    v_pk_fma_f32 v[238:239], v[238:239], v[238:239], v[246:247]
    v_rcp_f32 v232, v232
    v_rcp_f32 v233, v233
    v_rcp_f32 v234, v234
    v_rcp_f32 v235, v235
    v_rcp_f32 v236, v236
    v_rcp_f32 v237, v237
    v_rcp_f32 v238, v238
    v_rcp_f32 v239, v239
    v_pk_mul_f32 v[232:233], v[232:233], v[240:241] clamp
    v_pk_mul_f32 v[234:235], v[234:235], v[242:243] clamp
    v_pk_mul_f32 v[236:237], v[236:237], v[244:245] clamp
    v_pk_mul_f32 v[238:239], v[238:239], v[246:247] clamp
    v_pk_mul_f32 v[232:233], v[232:233], v[136:137]
    v_pk_mul_f32 v[234:235], v[234:235], v[138:139]
    v_pk_mul_f32 v[236:237], v[236:237], v[140:141]
    v_pk_mul_f32 v[238:239], v[238:239], v[142:143]
    v_cvt_pk_bf16_f32 v248, v232, v233
    v_cvt_pk_bf16_f32 v249, v234, v235
    v_cvt_pk_bf16_f32 v250, v236, v237
    v_cvt_pk_bf16_f32 v251, v238, v239
    buffer_store_dwordx4 v[248:251], v14, s[40:43], s63 offen offset:0 sc1
    s_waitcnt lgkmcnt(9)
    v_pk_add_f32 v[144:145], v[144:145], v[192:193]
    v_pk_add_f32 v[146:147], v[146:147], v[194:195]
    s_waitcnt lgkmcnt(8)
    v_pk_add_f32 v[148:149], v[148:149], v[196:197]
    v_pk_add_f32 v[150:151], v[150:151], v[198:199]
    v_pk_mul_f32 v[232:233], v[144:145], s[66:67]
    v_pk_mul_f32 v[234:235], v[146:147], s[66:67]
    v_pk_mul_f32 v[236:237], v[148:149], s[66:67]
    v_pk_mul_f32 v[238:239], v[150:151], s[66:67]
    v_exp_f32 v232, v232
    v_exp_f32 v233, v233
    v_exp_f32 v234, v234
    v_exp_f32 v235, v235
    v_exp_f32 v236, v236
    v_exp_f32 v237, v237
    v_exp_f32 v238, v238
    v_exp_f32 v239, v239
    v_pk_add_f32 v[240:241], v[232:233], s[68:69]
    v_pk_add_f32 v[242:243], v[234:235], s[68:69]
    v_pk_add_f32 v[244:245], v[236:237], s[68:69]
    v_pk_add_f32 v[246:247], v[238:239], s[68:69]
    v_pk_fma_f32 v[232:233], v[232:233], v[232:233], v[240:241]
    v_pk_fma_f32 v[234:235], v[234:235], v[234:235], v[242:243]
    v_pk_fma_f32 v[236:237], v[236:237], v[236:237], v[244:245]
    v_pk_fma_f32 v[238:239], v[238:239], v[238:239], v[246:247]
    v_rcp_f32 v232, v232
    v_rcp_f32 v233, v233
    v_rcp_f32 v234, v234
    v_rcp_f32 v235, v235
    v_rcp_f32 v236, v236
    v_rcp_f32 v237, v237
    v_rcp_f32 v238, v238
    v_rcp_f32 v239, v239
    v_pk_mul_f32 v[232:233], v[232:233], v[240:241] clamp
    v_pk_mul_f32 v[234:235], v[234:235], v[242:243] clamp
    v_pk_mul_f32 v[236:237], v[236:237], v[244:245] clamp
    v_pk_mul_f32 v[238:239], v[238:239], v[246:247] clamp
    v_pk_mul_f32 v[232:233], v[232:233], v[144:145]
    v_pk_mul_f32 v[234:235], v[234:235], v[146:147]
    v_pk_mul_f32 v[236:237], v[236:237], v[148:149]
    v_pk_mul_f32 v[238:239], v[238:239], v[150:151]
    v_cvt_pk_bf16_f32 v252, v232, v233
    v_cvt_pk_bf16_f32 v253, v234, v235
    v_cvt_pk_bf16_f32 v254, v236, v237
    v_cvt_pk_bf16_f32 v255, v238, v239
    buffer_store_dwordx4 v[252:255], v14, s[40:43], s63 offen offset:2048 sc1
    s_waitcnt lgkmcnt(7)
    v_pk_add_f32 v[152:153], v[152:153], v[200:201]
    v_pk_add_f32 v[154:155], v[154:155], v[202:203]
    s_waitcnt lgkmcnt(6)
    v_pk_add_f32 v[156:157], v[156:157], v[204:205]
    v_pk_add_f32 v[158:159], v[158:159], v[206:207]
    v_pk_mul_f32 v[232:233], v[152:153], s[66:67]
    v_pk_mul_f32 v[234:235], v[154:155], s[66:67]
    v_pk_mul_f32 v[236:237], v[156:157], s[66:67]
    v_pk_mul_f32 v[238:239], v[158:159], s[66:67]
    v_exp_f32 v232, v232
    v_exp_f32 v233, v233
    v_exp_f32 v234, v234
    v_exp_f32 v235, v235
    v_exp_f32 v236, v236
    v_exp_f32 v237, v237
    v_exp_f32 v238, v238
    v_exp_f32 v239, v239
    v_pk_add_f32 v[240:241], v[232:233], s[68:69]
    v_pk_add_f32 v[242:243], v[234:235], s[68:69]
    v_pk_add_f32 v[244:245], v[236:237], s[68:69]
    v_pk_add_f32 v[246:247], v[238:239], s[68:69]
    v_pk_fma_f32 v[232:233], v[232:233], v[232:233], v[240:241]
    v_pk_fma_f32 v[234:235], v[234:235], v[234:235], v[242:243]
    v_pk_fma_f32 v[236:237], v[236:237], v[236:237], v[244:245]
    v_pk_fma_f32 v[238:239], v[238:239], v[238:239], v[246:247]
    v_rcp_f32 v232, v232
    v_rcp_f32 v233, v233
    v_rcp_f32 v234, v234
    v_rcp_f32 v235, v235
    v_rcp_f32 v236, v236
    v_rcp_f32 v237, v237
    v_rcp_f32 v238, v238
    v_rcp_f32 v239, v239
    v_pk_mul_f32 v[232:233], v[232:233], v[240:241] clamp
    v_pk_mul_f32 v[234:235], v[234:235], v[242:243] clamp
    v_pk_mul_f32 v[236:237], v[236:237], v[244:245] clamp
    v_pk_mul_f32 v[238:239], v[238:239], v[246:247] clamp
    v_pk_mul_f32 v[232:233], v[232:233], v[152:153]
    v_pk_mul_f32 v[234:235], v[234:235], v[154:155]
    v_pk_mul_f32 v[236:237], v[236:237], v[156:157]
    v_pk_mul_f32 v[238:239], v[238:239], v[158:159]
    v_cvt_pk_bf16_f32 v248, v232, v233
    v_cvt_pk_bf16_f32 v249, v234, v235
    v_cvt_pk_bf16_f32 v250, v236, v237
    v_cvt_pk_bf16_f32 v251, v238, v239
    buffer_store_dwordx4 v[248:251], v14, s[40:43], s64 offen offset:0 sc1
    s_waitcnt lgkmcnt(5)
    v_pk_add_f32 v[160:161], v[160:161], v[208:209]
    v_pk_add_f32 v[162:163], v[162:163], v[210:211]
    s_waitcnt lgkmcnt(4)
    v_pk_add_f32 v[164:165], v[164:165], v[212:213]
    v_pk_add_f32 v[166:167], v[166:167], v[214:215]
    v_pk_mul_f32 v[232:233], v[160:161], s[66:67]
    v_pk_mul_f32 v[234:235], v[162:163], s[66:67]
    v_pk_mul_f32 v[236:237], v[164:165], s[66:67]
    v_pk_mul_f32 v[238:239], v[166:167], s[66:67]
    v_exp_f32 v232, v232
    v_exp_f32 v233, v233
    v_exp_f32 v234, v234
    v_exp_f32 v235, v235
    v_exp_f32 v236, v236
    v_exp_f32 v237, v237
    v_exp_f32 v238, v238
    v_exp_f32 v239, v239
    v_pk_add_f32 v[240:241], v[232:233], s[68:69]
    v_pk_add_f32 v[242:243], v[234:235], s[68:69]
    v_pk_add_f32 v[244:245], v[236:237], s[68:69]
    v_pk_add_f32 v[246:247], v[238:239], s[68:69]
    v_pk_fma_f32 v[232:233], v[232:233], v[232:233], v[240:241]
    v_pk_fma_f32 v[234:235], v[234:235], v[234:235], v[242:243]
    v_pk_fma_f32 v[236:237], v[236:237], v[236:237], v[244:245]
    v_pk_fma_f32 v[238:239], v[238:239], v[238:239], v[246:247]
    v_rcp_f32 v232, v232
    v_rcp_f32 v233, v233
    v_rcp_f32 v234, v234
    v_rcp_f32 v235, v235
    v_rcp_f32 v236, v236
    v_rcp_f32 v237, v237
    v_rcp_f32 v238, v238
    v_rcp_f32 v239, v239
    v_pk_mul_f32 v[232:233], v[232:233], v[240:241] clamp
    v_pk_mul_f32 v[234:235], v[234:235], v[242:243] clamp
    v_pk_mul_f32 v[236:237], v[236:237], v[244:245] clamp
    v_pk_mul_f32 v[238:239], v[238:239], v[246:247] clamp
    v_pk_mul_f32 v[232:233], v[232:233], v[160:161]
    v_pk_mul_f32 v[234:235], v[234:235], v[162:163]
    v_pk_mul_f32 v[236:237], v[236:237], v[164:165]
    v_pk_mul_f32 v[238:239], v[238:239], v[166:167]
    v_cvt_pk_bf16_f32 v252, v232, v233
    v_cvt_pk_bf16_f32 v253, v234, v235
    v_cvt_pk_bf16_f32 v254, v236, v237
    v_cvt_pk_bf16_f32 v255, v238, v239
    buffer_store_dwordx4 v[252:255], v14, s[40:43], s64 offen offset:2048 sc1
    s_waitcnt lgkmcnt(3)
    v_pk_add_f32 v[168:169], v[168:169], v[216:217]
    v_pk_add_f32 v[170:171], v[170:171], v[218:219]
    s_waitcnt lgkmcnt(2)
    v_pk_add_f32 v[172:173], v[172:173], v[220:221]
    v_pk_add_f32 v[174:175], v[174:175], v[222:223]
    v_pk_mul_f32 v[232:233], v[168:169], s[66:67]
    v_pk_mul_f32 v[234:235], v[170:171], s[66:67]
    v_pk_mul_f32 v[236:237], v[172:173], s[66:67]
    v_pk_mul_f32 v[238:239], v[174:175], s[66:67]
    v_exp_f32 v232, v232
    v_exp_f32 v233, v233
    v_exp_f32 v234, v234
    v_exp_f32 v235, v235
    v_exp_f32 v236, v236
    v_exp_f32 v237, v237
    v_exp_f32 v238, v238
    v_exp_f32 v239, v239
    v_pk_add_f32 v[240:241], v[232:233], s[68:69]
    v_pk_add_f32 v[242:243], v[234:235], s[68:69]
    v_pk_add_f32 v[244:245], v[236:237], s[68:69]
    v_pk_add_f32 v[246:247], v[238:239], s[68:69]
    v_pk_fma_f32 v[232:233], v[232:233], v[232:233], v[240:241]
    v_pk_fma_f32 v[234:235], v[234:235], v[234:235], v[242:243]
    v_pk_fma_f32 v[236:237], v[236:237], v[236:237], v[244:245]
    v_pk_fma_f32 v[238:239], v[238:239], v[238:239], v[246:247]
    v_rcp_f32 v232, v232
    v_rcp_f32 v233, v233
    v_rcp_f32 v234, v234
    v_rcp_f32 v235, v235
    v_rcp_f32 v236, v236
    v_rcp_f32 v237, v237
    v_rcp_f32 v238, v238
    v_rcp_f32 v239, v239
    v_pk_mul_f32 v[232:233], v[232:233], v[240:241] clamp
    v_pk_mul_f32 v[234:235], v[234:235], v[242:243] clamp
    v_pk_mul_f32 v[236:237], v[236:237], v[244:245] clamp
    v_pk_mul_f32 v[238:239], v[238:239], v[246:247] clamp
    v_pk_mul_f32 v[232:233], v[232:233], v[168:169]
    v_pk_mul_f32 v[234:235], v[234:235], v[170:171]
    v_pk_mul_f32 v[236:237], v[236:237], v[172:173]
    v_pk_mul_f32 v[238:239], v[238:239], v[174:175]
    v_cvt_pk_bf16_f32 v248, v232, v233
    v_cvt_pk_bf16_f32 v249, v234, v235
    v_cvt_pk_bf16_f32 v250, v236, v237
    v_cvt_pk_bf16_f32 v251, v238, v239
    buffer_store_dwordx4 v[248:251], v14, s[40:43], s65 offen offset:0 sc1
    s_waitcnt lgkmcnt(1)
    v_pk_add_f32 v[176:177], v[176:177], v[224:225]
    v_pk_add_f32 v[178:179], v[178:179], v[226:227]
    s_waitcnt lgkmcnt(0)
    v_pk_add_f32 v[180:181], v[180:181], v[228:229]
    v_pk_add_f32 v[182:183], v[182:183], v[230:231]
    v_pk_mul_f32 v[232:233], v[176:177], s[66:67]
    v_pk_mul_f32 v[234:235], v[178:179], s[66:67]
    v_pk_mul_f32 v[236:237], v[180:181], s[66:67]
    v_pk_mul_f32 v[238:239], v[182:183], s[66:67]
    v_exp_f32 v232, v232
    v_exp_f32 v233, v233
    v_exp_f32 v234, v234
    v_exp_f32 v235, v235
    v_exp_f32 v236, v236
    v_exp_f32 v237, v237
    v_exp_f32 v238, v238
    v_exp_f32 v239, v239
    v_pk_add_f32 v[240:241], v[232:233], s[68:69]
    v_pk_add_f32 v[242:243], v[234:235], s[68:69]
    v_pk_add_f32 v[244:245], v[236:237], s[68:69]
    v_pk_add_f32 v[246:247], v[238:239], s[68:69]
    v_pk_fma_f32 v[232:233], v[232:233], v[232:233], v[240:241]
    v_pk_fma_f32 v[234:235], v[234:235], v[234:235], v[242:243]
    v_pk_fma_f32 v[236:237], v[236:237], v[236:237], v[244:245]
    v_pk_fma_f32 v[238:239], v[238:239], v[238:239], v[246:247]
    v_rcp_f32 v232, v232
    v_rcp_f32 v233, v233
    v_rcp_f32 v234, v234
    v_rcp_f32 v235, v235
    v_rcp_f32 v236, v236
    v_rcp_f32 v237, v237
    v_rcp_f32 v238, v238
    v_rcp_f32 v239, v239
    v_pk_mul_f32 v[232:233], v[232:233], v[240:241] clamp
    v_pk_mul_f32 v[234:235], v[234:235], v[242:243] clamp
    v_pk_mul_f32 v[236:237], v[236:237], v[244:245] clamp
    v_pk_mul_f32 v[238:239], v[238:239], v[246:247] clamp
    v_pk_mul_f32 v[232:233], v[232:233], v[176:177]
    v_pk_mul_f32 v[234:235], v[234:235], v[178:179]
    v_pk_mul_f32 v[236:237], v[236:237], v[180:181]
    v_pk_mul_f32 v[238:239], v[238:239], v[182:183]
    v_cvt_pk_bf16_f32 v252, v232, v233
    v_cvt_pk_bf16_f32 v253, v234, v235
    v_cvt_pk_bf16_f32 v254, v236, v237
    v_cvt_pk_bf16_f32 v255, v238, v239
    buffer_store_dwordx4 v[252:255], v14, s[40:43], s65 offen offset:2048 sc1
    s_setprio 1
    s_branch spin_7
spin_6:
    s_sleep 1
spin_7:
    s_nop 0
    ds_read_b32 v234, v4 offset:72
    s_waitcnt lgkmcnt(0)
    v_readfirstlane_b32 s55, v234
    s_nop 0
    s_cmp_lt_u32 s55, 4
    s_cbranch_scc1 spin_6
    s_add_u32 s77, s78, 0
    buffer_load_dwordx4 v[16:19], v3, s[44:47], s77 offen sc1
    buffer_load_dwordx4 v[20:23], v3, s[44:47], s77 offen offset:1024 sc1
    s_add_u32 s77, s78, 8192
    buffer_load_dwordx4 v[24:27], v3, s[44:47], s77 offen sc1
    buffer_load_dwordx4 v[28:31], v3, s[44:47], s77 offen offset:1024 sc1
    s_mov_b32 s32, s22
    s_mov_b32 s33, s23
    s_mov_b32 s34, 20971520
    s_mov_b32 s35, 0x20000
    v_mov_b32 v240, 1
    v_mov_b32 v242, s56
    v_mov_b32 v243, s57
    v_and_b32 v244, 7, v1
    v_lshlrev_b32 v244, 7, v244
    v_lshlrev_b32 v245, 3, v1
    s_lshl_b32 s52, s24, 10
    s_add_u32 s52, s52, 65536
    s_lshl_b32 s54, s25, 7
    s_add_u32 s54, s54, s52
    s_waitcnt vmcnt(4)
    s_mov_b64 exec, 1
    ds_add_rtn_u32 v241, v4, v240 offset:88
    s_mov_b64 exec, -1
    s_waitcnt lgkmcnt(0)
    v_readfirstlane_b32 s55, v241
    s_nop 0
    s_mov_b32 s59, s55
    s_cmp_lg_u32 s59, 3
    s_cbranch_scc1 skip_11
    s_mov_b64 exec, 65535
    buffer_store_dwordx2 v[242:243], v245, s[32:35], s54 offen sc1
    s_mov_b64 exec, -1
skip_11:
    s_lshl_b32 s54, s60, 10
    v_add_u32_e64 v14, s54, v12
    v_xor_b32 v15, 1024, v14
    s_add_u32 s77, s78, 16384
    buffer_load_dwordx4 v[32:35], v3, s[44:47], s77 offen sc1
    buffer_load_dwordx4 v[36:39], v3, s[44:47], s77 offen offset:1024 sc1
    s_add_u32 s77, s78, 24576
    buffer_load_dwordx4 v[40:43], v3, s[44:47], s77 offen sc1
    buffer_load_dwordx4 v[44:47], v3, s[44:47], s77 offen offset:1024 sc1
    s_add_u32 s77, s78, 32768
    buffer_load_dwordx4 v[48:51], v3, s[44:47], s77 offen sc1
    buffer_load_dwordx4 v[52:55], v3, s[44:47], s77 offen offset:1024 sc1
    s_add_u32 s77, s78, 40960
    buffer_load_dwordx4 v[56:59], v3, s[44:47], s77 offen sc1
    buffer_load_dwordx4 v[60:63], v3, s[44:47], s77 offen offset:1024 sc1
    s_add_u32 s77, s78, 49152
    buffer_load_dwordx4 v[64:67], v3, s[44:47], s77 offen sc1
    buffer_load_dwordx4 v[68:71], v3, s[44:47], s77 offen offset:1024 sc1
    s_add_u32 s77, s78, 57344
    buffer_load_dwordx4 v[72:75], v3, s[44:47], s77 offen sc1
    buffer_load_dwordx4 v[76:79], v3, s[44:47], s77 offen offset:1024 sc1
    s_add_u32 s77, s78, 65536
    buffer_load_dwordx4 v[80:83], v3, s[44:47], s77 offen sc1
    buffer_load_dwordx4 v[84:87], v3, s[44:47], s77 offen offset:1024 sc1
    s_add_u32 s77, s78, 73728
    buffer_load_dwordx4 v[88:91], v3, s[44:47], s77 offen sc1
    buffer_load_dwordx4 v[92:95], v3, s[44:47], s77 offen offset:1024 sc1
    s_add_u32 s77, s78, 81920
    buffer_load_dwordx4 v[96:99], v3, s[44:47], s77 offen sc1
    buffer_load_dwordx4 v[100:103], v3, s[44:47], s77 offen offset:1024 sc1
    s_cmp_lg_u32 s59, 3
    s_cbranch_scc1 skip_12
    buffer_load_dwordx2 v[232:233], v244, s[32:35], s52 offen sc1
skip_12:
    s_add_u32 s77, s78, 90112
    buffer_load_dwordx4 v[104:107], v3, s[44:47], s77 offen sc1
    buffer_load_dwordx4 v[108:111], v3, s[44:47], s77 offen offset:1024 sc1
    s_add_u32 s77, s78, 98304
    buffer_load_dwordx4 v[112:115], v3, s[44:47], s77 offen sc1
    buffer_load_dwordx4 v[116:119], v3, s[44:47], s77 offen offset:1024 sc1
    s_add_u32 s77, s78, 106496
    buffer_load_dwordx4 v[120:123], v3, s[44:47], s77 offen sc1
    buffer_load_dwordx4 v[124:127], v3, s[44:47], s77 offen offset:1024 sc1
    s_add_u32 s77, s78, 114688
    buffer_load_dwordx4 v[128:131], v3, s[44:47], s77 offen sc1
    buffer_load_dwordx4 v[132:135], v3, s[44:47], s77 offen offset:1024 sc1
    s_mov_b32 s58, 0
    s_cmp_lg_u32 s59, 3
    s_cbranch_scc1 nopollB_8
    s_waitcnt vmcnt(8)
pollB_9:
    v_xor_b32 v232, s56, v232
    v_xor_b32 v233, s57, v233
    v_or_b32 v232, v232, v233
    v_cmp_ne_u32 vcc, 0, v232
    s_cbranch_vccz goB_10
    buffer_load_dwordx2 v[232:233], v244, s[32:35], s52 offen sc1
    s_waitcnt vmcnt(0)
    s_add_u32 s58, s58, 1
    s_cmp_lt_u32 s58, 200000
    s_cbranch_scc1 pollB_9
goB_10:
    s_mov_b64 exec, 1
    ds_add_u32 v4, v240 offset:92
    s_mov_b64 exec, -1
nopollB_8:
    v_and_b32 v10, 15, v1
    s_lshl_b32 s54, s27, 4
    v_add_u32 v10, s54, v10
    v_lshlrev_b32 v13, 2, v10
    v_mul_u32_u24 v10, 1040, v10
    v_and_b32 v2, 48, v1
    v_add_u32 v11, v2, v10
    ds_read_b128 v[136:139], v11 offset:18304
    ds_read_b128 v[140:143], v2 offset:16896
    ds_read_b128 v[144:147], v11 offset:18368
    ds_read_b128 v[148:151], v2 offset:16960
    ds_read_b128 v[152:155], v11 offset:18432
    ds_read_b128 v[156:159], v2 offset:17024
    ds_read_b128 v[160:163], v11 offset:18496
    ds_read_b128 v[164:167], v2 offset:17088
    ds_read_b128 v[168:171], v11 offset:18560
    ds_read_b128 v[172:175], v2 offset:17152
    ds_read_b128 v[176:179], v11 offset:18624
    ds_read_b128 v[180:183], v2 offset:17216
    s_waitcnt lgkmcnt(10)
    v_mfma_f32_16x16x32_bf16 v[192:195], v[140:143], v[136:139], 0
    ds_read_b128 v[184:187], v11 offset:18688
    ds_read_b128 v[188:191], v2 offset:17280
    s_waitcnt lgkmcnt(10)
    v_mfma_f32_16x16x32_bf16 v[196:199], v[148:151], v[144:147], 0
    ds_read_b128 v[136:139], v11 offset:18752
    ds_read_b128 v[140:143], v2 offset:17344
    s_waitcnt lgkmcnt(10)
    v_mfma_f32_16x16x32_bf16 v[192:195], v[156:159], v[152:155], v[192:195]
    ds_read_b128 v[144:147], v11 offset:18816
    ds_read_b128 v[148:151], v2 offset:17408
    s_waitcnt lgkmcnt(10)
    v_mfma_f32_16x16x32_bf16 v[196:199], v[164:167], v[160:163], v[196:199]
    ds_read_b128 v[152:155], v11 offset:18880
    ds_read_b128 v[156:159], v2 offset:17472
    s_waitcnt lgkmcnt(10)
    v_mfma_f32_16x16x32_bf16 v[192:195], v[172:175], v[168:171], v[192:195]
    ds_read_b128 v[160:163], v11 offset:18944
    ds_read_b128 v[164:167], v2 offset:17536
    s_waitcnt lgkmcnt(10)
    v_mfma_f32_16x16x32_bf16 v[196:199], v[180:183], v[176:179], v[196:199]
    ds_read_b128 v[168:171], v11 offset:19008
    ds_read_b128 v[172:175], v2 offset:17600
    s_waitcnt lgkmcnt(10)
    v_mfma_f32_16x16x32_bf16 v[192:195], v[188:191], v[184:187], v[192:195]
    ds_read_b128 v[176:179], v11 offset:19072
    ds_read_b128 v[180:183], v2 offset:17664
    s_waitcnt lgkmcnt(10)
    v_mfma_f32_16x16x32_bf16 v[196:199], v[140:143], v[136:139], v[196:199]
    ds_read_b128 v[184:187], v11 offset:19136
    ds_read_b128 v[188:191], v2 offset:17728
    s_waitcnt lgkmcnt(10)
    v_mfma_f32_16x16x32_bf16 v[192:195], v[148:151], v[144:147], v[192:195]
    ds_read_b128 v[136:139], v11 offset:19200
    ds_read_b128 v[140:143], v2 offset:17792
    s_waitcnt lgkmcnt(10)
    v_mfma_f32_16x16x32_bf16 v[196:199], v[156:159], v[152:155], v[196:199]
    ds_read_b128 v[144:147], v11 offset:19264
    ds_read_b128 v[148:151], v2 offset:17856
    s_waitcnt lgkmcnt(10)
    v_mfma_f32_16x16x32_bf16 v[192:195], v[164:167], v[160:163], v[192:195]
    s_waitcnt lgkmcnt(8)
    v_mfma_f32_16x16x32_bf16 v[196:199], v[172:175], v[168:171], v[196:199]
    s_waitcnt lgkmcnt(6)
    v_mfma_f32_16x16x32_bf16 v[192:195], v[180:183], v[176:179], v[192:195]
    s_waitcnt lgkmcnt(4)
    v_mfma_f32_16x16x32_bf16 v[196:199], v[188:191], v[184:187], v[196:199]
    s_waitcnt lgkmcnt(2)
    v_mfma_f32_16x16x32_bf16 v[192:195], v[140:143], v[136:139], v[192:195]
    s_waitcnt lgkmcnt(0)
    v_mfma_f32_16x16x32_bf16 v[196:199], v[148:151], v[144:147], v[196:199]
    s_nop 7
    v_add_f32 v192, v192, v196
    v_mul_f32 v192, 0xbfb8aa3b, v192
    v_exp_f32 v192, v192
    s_nop 0
    v_add_f32_e64 v192, 1.0, v192
    v_rcp_f32 v192, v192
    ds_write_b32 v13, v192 offset:17920
    s_waitcnt lgkmcnt(0)
spin_13:
    ds_read_b32 v234, v4 offset:92
    s_waitcnt lgkmcnt(0)
    v_readfirstlane_b32 s55, v234
    s_nop 0
    s_cmp_lt_u32 s55, 1
    s_cbranch_scc1 spin_13
    s_add_u32 s62, s78, 0
    buffer_load_dwordx4 v[200:203], v14, s[40:43], s62 offen sc1
    buffer_load_dwordx4 v[204:207], v15, s[40:43], s62 offen sc1
    s_add_u32 s62, s78, 8192
    buffer_load_dwordx4 v[208:211], v14, s[40:43], s62 offen sc1
    buffer_load_dwordx4 v[212:215], v15, s[40:43], s62 offen sc1
    s_add_u32 s62, s78, 16384
    buffer_load_dwordx4 v[216:219], v14, s[40:43], s62 offen sc1
    buffer_load_dwordx4 v[220:223], v15, s[40:43], s62 offen sc1
    s_add_u32 s62, s78, 24576
    buffer_load_dwordx4 v[224:227], v14, s[40:43], s62 offen sc1
    buffer_load_dwordx4 v[228:231], v15, s[40:43], s62 offen sc1
    s_add_u32 s62, s78, 32768
    buffer_load_dwordx4 v[232:235], v14, s[40:43], s62 offen sc1
    buffer_load_dwordx4 v[236:239], v15, s[40:43], s62 offen sc1
    s_add_u32 s62, s78, 40960
    buffer_load_dwordx4 v[240:243], v14, s[40:43], s62 offen sc1
    buffer_load_dwordx4 v[244:247], v15, s[40:43], s62 offen sc1
    s_waitcnt vmcnt(11)
    v_mfma_f32_32x32x16_bf16 v[136:151], v[16:19], v[200:203], 0
    s_add_u32 s62, s78, 49152
    buffer_load_dwordx4 v[248:251], v14, s[40:43], s62 offen sc1
    s_waitcnt vmcnt(11)
    v_mfma_f32_32x32x16_bf16 v[152:167], v[16:19], v[204:207], 0
    v_mfma_f32_32x32x16_bf16 v[168:183], v[20:23], v[200:203], 0
    buffer_load_dwordx4 v[252:255], v15, s[40:43], s62 offen sc1
    v_mfma_f32_32x32x16_bf16 v[184:199], v[20:23], v[204:207], 0
    s_waitcnt vmcnt(11)
    v_mfma_f32_32x32x16_bf16 v[136:151], v[24:27], v[208:211], v[136:151]
    s_add_u32 s62, s78, 57344
    buffer_load_dwordx4 v[200:203], v14, s[40:43], s62 offen sc1
    s_waitcnt vmcnt(11)
    v_mfma_f32_32x32x16_bf16 v[152:167], v[24:27], v[212:215], v[152:167]
    v_mfma_f32_32x32x16_bf16 v[168:183], v[28:31], v[208:211], v[168:183]
    buffer_load_dwordx4 v[204:207], v15, s[40:43], s62 offen sc1
    v_mfma_f32_32x32x16_bf16 v[184:199], v[28:31], v[212:215], v[184:199]
    s_waitcnt vmcnt(11)
    v_mfma_f32_32x32x16_bf16 v[136:151], v[32:35], v[216:219], v[136:151]
    s_add_u32 s62, s78, 65536
    buffer_load_dwordx4 v[208:211], v14, s[40:43], s62 offen sc1
    s_waitcnt vmcnt(11)
    v_mfma_f32_32x32x16_bf16 v[152:167], v[32:35], v[220:223], v[152:167]
    v_mfma_f32_32x32x16_bf16 v[168:183], v[36:39], v[216:219], v[168:183]
    buffer_load_dwordx4 v[212:215], v15, s[40:43], s62 offen sc1
    v_mfma_f32_32x32x16_bf16 v[184:199], v[36:39], v[220:223], v[184:199]
    s_waitcnt vmcnt(11)
    v_mfma_f32_32x32x16_bf16 v[136:151], v[40:43], v[224:227], v[136:151]
    s_add_u32 s62, s78, 73728
    buffer_load_dwordx4 v[216:219], v14, s[40:43], s62 offen sc1
    s_waitcnt vmcnt(11)
    v_mfma_f32_32x32x16_bf16 v[152:167], v[40:43], v[228:231], v[152:167]
    v_mfma_f32_32x32x16_bf16 v[168:183], v[44:47], v[224:227], v[168:183]
    buffer_load_dwordx4 v[220:223], v15, s[40:43], s62 offen sc1
    v_mfma_f32_32x32x16_bf16 v[184:199], v[44:47], v[228:231], v[184:199]
    s_waitcnt vmcnt(11)
    v_mfma_f32_32x32x16_bf16 v[136:151], v[48:51], v[232:235], v[136:151]
    s_add_u32 s62, s78, 81920
    buffer_load_dwordx4 v[224:227], v14, s[40:43], s62 offen sc1
    s_waitcnt vmcnt(11)
    v_mfma_f32_32x32x16_bf16 v[152:167], v[48:51], v[236:239], v[152:167]
    v_mfma_f32_32x32x16_bf16 v[168:183], v[52:55], v[232:235], v[168:183]
    buffer_load_dwordx4 v[228:231], v15, s[40:43], s62 offen sc1
    v_mfma_f32_32x32x16_bf16 v[184:199], v[52:55], v[236:239], v[184:199]
    s_waitcnt vmcnt(11)
    v_mfma_f32_32x32x16_bf16 v[136:151], v[56:59], v[240:243], v[136:151]
    s_add_u32 s62, s78, 90112
    buffer_load_dwordx4 v[232:235], v14, s[40:43], s62 offen sc1
    s_waitcnt vmcnt(11)
    v_mfma_f32_32x32x16_bf16 v[152:167], v[56:59], v[244:247], v[152:167]
    v_mfma_f32_32x32x16_bf16 v[168:183], v[60:63], v[240:243], v[168:183]
    buffer_load_dwordx4 v[236:239], v15, s[40:43], s62 offen sc1
    v_mfma_f32_32x32x16_bf16 v[184:199], v[60:63], v[244:247], v[184:199]
    s_waitcnt vmcnt(11)
    v_mfma_f32_32x32x16_bf16 v[136:151], v[64:67], v[248:251], v[136:151]
    s_add_u32 s62, s78, 98304
    buffer_load_dwordx4 v[240:243], v14, s[40:43], s62 offen sc1
    s_waitcnt vmcnt(11)
    v_mfma_f32_32x32x16_bf16 v[152:167], v[64:67], v[252:255], v[152:167]
    v_mfma_f32_32x32x16_bf16 v[168:183], v[68:71], v[248:251], v[168:183]
    buffer_load_dwordx4 v[244:247], v15, s[40:43], s62 offen sc1
    v_mfma_f32_32x32x16_bf16 v[184:199], v[68:71], v[252:255], v[184:199]
    ds_write_b8 v8, v9 offset:32
    s_waitcnt vmcnt(11)
    v_mfma_f32_32x32x16_bf16 v[136:151], v[72:75], v[200:203], v[136:151]
    s_add_u32 s62, s78, 106496
    buffer_load_dwordx4 v[248:251], v14, s[40:43], s62 offen sc1
    s_waitcnt vmcnt(11)
    v_mfma_f32_32x32x16_bf16 v[152:167], v[72:75], v[204:207], v[152:167]
    v_mfma_f32_32x32x16_bf16 v[168:183], v[76:79], v[200:203], v[168:183]
    buffer_load_dwordx4 v[252:255], v15, s[40:43], s62 offen sc1
    v_mfma_f32_32x32x16_bf16 v[184:199], v[76:79], v[204:207], v[184:199]
    s_waitcnt vmcnt(11)
    v_mfma_f32_32x32x16_bf16 v[136:151], v[80:83], v[208:211], v[136:151]
    s_add_u32 s62, s78, 114688
    buffer_load_dwordx4 v[200:203], v14, s[40:43], s62 offen sc1
    s_waitcnt vmcnt(11)
    v_mfma_f32_32x32x16_bf16 v[152:167], v[80:83], v[212:215], v[152:167]
    v_mfma_f32_32x32x16_bf16 v[168:183], v[84:87], v[208:211], v[168:183]
    buffer_load_dwordx4 v[204:207], v15, s[40:43], s62 offen sc1
    v_mfma_f32_32x32x16_bf16 v[184:199], v[84:87], v[212:215], v[184:199]
    s_waitcnt vmcnt(11)
    v_mfma_f32_32x32x16_bf16 v[136:151], v[88:91], v[216:219], v[136:151]
    s_add_u32 s62, s78, 122880
    buffer_load_dwordx4 v[208:211], v14, s[40:43], s62 offen sc1
    s_waitcnt vmcnt(11)
    v_mfma_f32_32x32x16_bf16 v[152:167], v[88:91], v[220:223], v[152:167]
    s_add_u32 s53, s78, 122880
    buffer_load_dwordx4 v[16:19], v3, s[44:47], s53 offen offset:0 sc1
    v_mfma_f32_32x32x16_bf16 v[168:183], v[92:95], v[216:219], v[168:183]
    buffer_load_dwordx4 v[212:215], v15, s[40:43], s62 offen sc1
    v_mfma_f32_32x32x16_bf16 v[184:199], v[92:95], v[220:223], v[184:199]
    buffer_load_dwordx4 v[20:23], v3, s[44:47], s53 offen offset:1024 sc1
    s_waitcnt vmcnt(13)
    v_mfma_f32_32x32x16_bf16 v[136:151], v[96:99], v[224:227], v[136:151]
    s_add_u32 s62, s78, 131072
    buffer_load_dwordx4 v[216:219], v14, s[40:43], s62 offen sc1
    s_waitcnt vmcnt(13)
    v_mfma_f32_32x32x16_bf16 v[152:167], v[96:99], v[228:231], v[152:167]
    s_add_u32 s53, s78, 131072
    buffer_load_dwordx4 v[24:27], v3, s[44:47], s53 offen offset:0 sc1
    v_mfma_f32_32x32x16_bf16 v[168:183], v[100:103], v[224:227], v[168:183]
    buffer_load_dwordx4 v[220:223], v15, s[40:43], s62 offen sc1
    v_mfma_f32_32x32x16_bf16 v[184:199], v[100:103], v[228:231], v[184:199]
    buffer_load_dwordx4 v[28:31], v3, s[44:47], s53 offen offset:1024 sc1
    s_waitcnt vmcnt(15)
    v_mfma_f32_32x32x16_bf16 v[136:151], v[104:107], v[232:235], v[136:151]
    s_add_u32 s62, s78, 139264
    buffer_load_dwordx4 v[224:227], v14, s[40:43], s62 offen sc1
    s_waitcnt vmcnt(15)
    v_mfma_f32_32x32x16_bf16 v[152:167], v[104:107], v[236:239], v[152:167]
    s_add_u32 s53, s78, 139264
    buffer_load_dwordx4 v[32:35], v3, s[44:47], s53 offen offset:0 sc1
    v_mfma_f32_32x32x16_bf16 v[168:183], v[108:111], v[232:235], v[168:183]
    buffer_load_dwordx4 v[228:231], v15, s[40:43], s62 offen sc1
    v_mfma_f32_32x32x16_bf16 v[184:199], v[108:111], v[236:239], v[184:199]
    buffer_load_dwordx4 v[36:39], v3, s[44:47], s53 offen offset:1024 sc1
    s_waitcnt vmcnt(17)
    v_mfma_f32_32x32x16_bf16 v[136:151], v[112:115], v[240:243], v[136:151]
    s_add_u32 s62, s78, 147456
    buffer_load_dwordx4 v[232:235], v14, s[40:43], s62 offen sc1
    s_waitcnt vmcnt(17)
    v_mfma_f32_32x32x16_bf16 v[152:167], v[112:115], v[244:247], v[152:167]
    s_add_u32 s53, s78, 147456
    buffer_load_dwordx4 v[40:43], v3, s[44:47], s53 offen offset:0 sc1
    v_mfma_f32_32x32x16_bf16 v[168:183], v[116:119], v[240:243], v[168:183]
    buffer_load_dwordx4 v[236:239], v15, s[40:43], s62 offen sc1
    v_mfma_f32_32x32x16_bf16 v[184:199], v[116:119], v[244:247], v[184:199]
    buffer_load_dwordx4 v[44:47], v3, s[44:47], s53 offen offset:1024 sc1
    s_waitcnt vmcnt(19)
    v_mfma_f32_32x32x16_bf16 v[136:151], v[120:123], v[248:251], v[136:151]
    s_add_u32 s62, s78, 155648
    buffer_load_dwordx4 v[240:243], v14, s[40:43], s62 offen sc1
    s_waitcnt vmcnt(19)
    v_mfma_f32_32x32x16_bf16 v[152:167], v[120:123], v[252:255], v[152:167]
    s_add_u32 s53, s78, 155648
    buffer_load_dwordx4 v[48:51], v3, s[44:47], s53 offen offset:0 sc1
    v_mfma_f32_32x32x16_bf16 v[168:183], v[124:127], v[248:251], v[168:183]
    buffer_load_dwordx4 v[244:247], v15, s[40:43], s62 offen sc1
    v_mfma_f32_32x32x16_bf16 v[184:199], v[124:127], v[252:255], v[184:199]
    buffer_load_dwordx4 v[52:55], v3, s[44:47], s53 offen offset:1024 sc1
    s_waitcnt vmcnt(21)
    v_mfma_f32_32x32x16_bf16 v[136:151], v[128:131], v[200:203], v[136:151]
    s_add_u32 s62, s78, 163840
    buffer_load_dwordx4 v[248:251], v14, s[40:43], s62 offen sc1
    s_waitcnt vmcnt(21)
    v_mfma_f32_32x32x16_bf16 v[152:167], v[128:131], v[204:207], v[152:167]
    s_add_u32 s53, s78, 163840
    buffer_load_dwordx4 v[56:59], v3, s[44:47], s53 offen offset:0 sc1
    v_mfma_f32_32x32x16_bf16 v[168:183], v[132:135], v[200:203], v[168:183]
    buffer_load_dwordx4 v[252:255], v15, s[40:43], s62 offen sc1
    v_mfma_f32_32x32x16_bf16 v[184:199], v[132:135], v[204:207], v[184:199]
    buffer_load_dwordx4 v[60:63], v3, s[44:47], s53 offen offset:1024 sc1
    s_waitcnt vmcnt(22)
    s_nop 0
    v_mfma_f32_32x32x16_bf16 v[136:151], v[16:19], v[208:211], v[136:151]
    s_add_u32 s62, s78, 172032
    buffer_load_dwordx4 v[200:203], v14, s[40:43], s62 offen sc1
    s_waitcnt vmcnt(22)
    v_mfma_f32_32x32x16_bf16 v[152:167], v[16:19], v[212:215], v[152:167]
    s_add_u32 s53, s78, 172032
    buffer_load_dwordx4 v[64:67], v3, s[44:47], s53 offen offset:0 sc1
    s_waitcnt vmcnt(22)
    v_mfma_f32_32x32x16_bf16 v[168:183], v[20:23], v[208:211], v[168:183]
    buffer_load_dwordx4 v[204:207], v15, s[40:43], s62 offen sc1
    v_mfma_f32_32x32x16_bf16 v[184:199], v[20:23], v[212:215], v[184:199]
    buffer_load_dwordx4 v[68:71], v3, s[44:47], s53 offen offset:1024 sc1
    s_waitcnt vmcnt(22)
    v_mfma_f32_32x32x16_bf16 v[136:151], v[24:27], v[216:219], v[136:151]
    s_waitcnt vmcnt(21)
    v_mfma_f32_32x32x16_bf16 v[152:167], v[24:27], v[220:223], v[152:167]
    s_waitcnt vmcnt(20)
    v_mfma_f32_32x32x16_bf16 v[168:183], v[28:31], v[216:219], v[168:183]
    v_mfma_f32_32x32x16_bf16 v[184:199], v[28:31], v[220:223], v[184:199]
    s_waitcnt vmcnt(18)
    v_mfma_f32_32x32x16_bf16 v[136:151], v[32:35], v[224:227], v[136:151]
    s_waitcnt vmcnt(17)
    v_mfma_f32_32x32x16_bf16 v[152:167], v[32:35], v[228:231], v[152:167]
    s_waitcnt vmcnt(16)
    v_mfma_f32_32x32x16_bf16 v[168:183], v[36:39], v[224:227], v[168:183]
    v_mfma_f32_32x32x16_bf16 v[184:199], v[36:39], v[228:231], v[184:199]
    s_mul_i32 s52, s27, 12288
    s_add_u32 s52, s52, 84864
    v_add_u32 v2, s52, v12
    v_and_b32 v10, 31, v1
    s_and_b32 s52, s27, 1
    s_lshl_b32 s52, s52, 5
    v_add_u32 v10, s52, v10
    v_lshrrev_b32 v11, 5, v1
    s_lshr_b32 s52, s27, 1
    s_lshl_b32 s52, s52, 2
    v_add_u32 v11, s52, v11
    v_lshlrev_b32 v8, 2, v10
    v_and_b32 v13, 7, v10
    v_xor_b32 v13, v13, v11
    v_lshlrev_b32 v3, 8, v10
    v_lshl_add_u32 v3, v13, 5, v3
    v_xor_b32 v13, 64, v3
    v_lshlrev_b32_e64 v9, 15, v10
    v_lshl_add_u32 v9, v11, 7, v9
    s_lshl_b32 s101, s24, 10
    s_lshl_b32 s52, s25, 4
    s_add_u32 s101, s101, s52
    s_lshl_b32 s52, s27, 11
    s_add_u32 s52, s52, 134016
    v_add_u32 v10, s52, v12
    s_waitcnt vmcnt(14)
    v_mfma_f32_32x32x16_bf16 v[136:151], v[40:43], v[232:235], v[136:151]
    s_waitcnt vmcnt(13)
    v_mfma_f32_32x32x16_bf16 v[152:167], v[40:43], v[236:239], v[152:167]
    s_waitcnt vmcnt(12)
    v_mfma_f32_32x32x16_bf16 v[168:183], v[44:47], v[232:235], v[168:183]
    v_mfma_f32_32x32x16_bf16 v[184:199], v[44:47], v[236:239], v[184:199]
    s_waitcnt vmcnt(10)
    v_mfma_f32_32x32x16_bf16 v[136:151], v[48:51], v[240:243], v[136:151]
    s_waitcnt vmcnt(9)
    v_mfma_f32_32x32x16_bf16 v[152:167], v[48:51], v[244:247], v[152:167]
    s_waitcnt vmcnt(8)
    v_mfma_f32_32x32x16_bf16 v[168:183], v[52:55], v[240:243], v[168:183]
    v_mfma_f32_32x32x16_bf16 v[184:199], v[52:55], v[244:247], v[184:199]
    s_xor_b32 s52, s27, 1
    s_mul_i32 s52, s52, 12288
    s_add_u32 s52, s52, 84864
    v_add_u32 v5, s52, v12
    s_xor_b32 s52, s27, 2
    s_mul_i32 s52, s52, 12288
    s_add_u32 s52, s52, 84864
    v_add_u32 v6, s52, v12
    s_xor_b32 s52, s27, 3
    s_mul_i32 s52, s52, 12288
    s_add_u32 s52, s52, 84864
    v_add_u32_e64 v7, s52, v12
    s_waitcnt vmcnt(5)
    v_mfma_f32_32x32x16_bf16 v[152:167], v[56:59], v[252:255], v[152:167]
    s_waitcnt vmcnt(1)
    v_mfma_f32_32x32x16_bf16 v[152:167], v[64:67], v[204:207], v[152:167]
    v_mfma_f32_32x32x16_bf16 v[184:199], v[60:63], v[252:255], v[184:199]
    s_waitcnt vmcnt(0)
    v_mfma_f32_32x32x16_bf16 v[184:199], v[68:71], v[204:207], v[184:199]
    v_mfma_f32_32x32x16_bf16 v[136:151], v[56:59], v[248:251], v[136:151]
    v_mfma_f32_32x32x16_bf16 v[136:151], v[64:67], v[200:203], v[136:151]
    s_nop 6
    ds_write_b128 v5, v[152:155] offset:0
    ds_write_b128 v5, v[156:159] offset:1024
    ds_write_b128 v7, v[160:163] offset:8192
    ds_write_b128 v7, v[164:167] offset:9216
    v_mfma_f32_32x32x16_bf16 v[168:183], v[60:63], v[248:251], v[168:183]
    ds_write_b128 v5, v[184:187] offset:2048
    ds_write_b128 v5, v[188:191] offset:3072
    v_mfma_f32_32x32x16_bf16 v[168:183], v[68:71], v[200:203], v[168:183]
    ds_write_b128 v7, v[192:195] offset:10240
    ds_write_b128 v7, v[196:199] offset:11264
    ds_write_b128 v6, v[144:147] offset:4096
    ds_write_b128 v6, v[148:151] offset:5120
    s_nop 7
    s_nop 0
    ds_write_b128 v6, v[176:179] offset:6144
    ds_write_b128 v6, v[180:183] offset:7168
    ds_write_b128 v10, v[140:143] offset:0
    ds_write_b128 v10, v[172:175] offset:1024
    s_waitcnt lgkmcnt(0)
    s_barrier
    ds_read_b32 v14, v8 offset:17920
    ds_read_b128 v[16:19], v2 offset:0
    ds_read_b128 v[24:27], v2 offset:2048
    ds_read_b128 v[32:35], v2 offset:4096
    ds_read_b128 v[40:43], v2 offset:6144
    ds_read_b128 v[48:51], v2 offset:8192
    ds_read_b128 v[56:59], v2 offset:10240
    ds_read_b128 v[64:67], v3 offset:0
    ds_read_b128 v[68:71], v3 offset:16
    s_waitcnt lgkmcnt(8)
    v_sub_f32 v14, 1.0, v14
    s_waitcnt lgkmcnt(7)
    v_pk_add_f32 v[136:137], v[136:137], v[16:17]
    v_pk_add_f32 v[138:139], v[138:139], v[18:19]
    s_waitcnt lgkmcnt(6)
    v_pk_add_f32 v[168:169], v[168:169], v[24:25]
    v_pk_add_f32 v[170:171], v[170:171], v[26:27]
    s_waitcnt lgkmcnt(5)
    v_pk_add_f32 v[136:137], v[136:137], v[32:33]
    v_pk_add_f32 v[138:139], v[138:139], v[34:35]
    s_waitcnt lgkmcnt(4)
    v_pk_add_f32 v[168:169], v[168:169], v[40:41]
    v_pk_add_f32 v[170:171], v[170:171], v[42:43]
    s_waitcnt lgkmcnt(3)
    v_pk_add_f32 v[136:137], v[136:137], v[48:49]
    v_pk_add_f32 v[138:139], v[138:139], v[50:51]
    s_waitcnt lgkmcnt(2)
    v_pk_add_f32 v[168:169], v[168:169], v[56:57]
    v_pk_add_f32 v[170:171], v[170:171], v[58:59]
    s_waitcnt lgkmcnt(1)
    v_fmac_f32 v64, v14, v136
    v_fmac_f32 v65, v14, v168
    v_fmac_f32 v66, v14, v137
    v_fmac_f32 v67, v14, v169
    s_waitcnt lgkmcnt(0)
    v_fmac_f32 v68, v14, v138
    v_fmac_f32 v69, v14, v170
    v_fmac_f32 v70, v14, v139
    v_fmac_f32 v71, v14, v171
    v_cvt_pk_bf16_f32 v80, v64, v65
    v_cvt_pk_bf16_f32 v81, v66, v67
    v_cvt_pk_bf16_f32 v82, v68, v69
    v_cvt_pk_bf16_f32 v83, v70, v71
    buffer_store_dwordx4 v[80:83], v9, s[48:51], s101 offen offset:0
    s_endpgm
L_F:
    s_mul_i32 s52, s24, 5
    s_add_u32 s52, s52, s25
    s_sub_u32 s52, s52, 8
    s_add_u32 s53, s24, 154
    s_cmp_eq_u32 s25, 2
    s_cselect_b32 s53, s53, 200
    s_cmp_ge_u32 s25, 3
    s_cselect_b32 s3, s52, s53
    s_cmp_eq_u32 s24, 0
    s_cselect_b32 s3, 200, s3
    s_waitcnt lgkmcnt(0)
    s_barrier
    v_and_b32 v2, 15, v1
    v_lshrrev_b32 v3, 4, v1
    s_mov_b32 s36, s12
    s_mov_b32 s37, s13
    s_mov_b32 s38, 1409024
    s_mov_b32 s39, 0x20000
    s_mul_i32 s52, s2, 5504
    s_mul_i32 s53, s27, 1408
    s_add_u32 s52, s52, s53
    v_mul_u32_u24 v232, 128, v1
    s_mov_b64 exec, 2047
    buffer_load_dword v199, v232, s[36:39], s52 offen
    s_mov_b64 exec, -1
    s_load_dwordx2 s[56:57], s[22:23], 0
    s_mov_b32 s32, s22
    s_mov_b32 s33, s23
    s_mov_b32 s34, 20971520
    s_mov_b32 s35, 0x20000
    v_mov_b32 v5, 1
    s_and_b32 s74, s27, 1
    s_lshr_b32 s75, s27, 1
    v_cvt_f32_u32 v9, v2
    v_cvt_f32_u32 v10, v3
    s_lshl_b32 s52, s75, 4
    v_add_u32 v232, s52, v2
    v_cmp_eq_u32 s[62:63], 0, v232
    v_cvt_f32_u32 v232, v232
    v_mul_f32 v232, 0x3c800000, v232
    v_mul_f32 v233, 0x41000000, v10
    v_mul_f32_e64 v233, v233, v232
    v_fmamk_f32 v235, v232, 0x3f800000, v233
    v_fmamk_f32 v236, v232, 0x40000000, v233
    v_fmamk_f32 v237, v232, 0x40400000, v233
    v_cos_f32 v238, v233
    v_cos_f32 v239, v235
    v_cos_f32 v240, v236
    v_cos_f32 v241, v237
    v_sin_f32 v242, v233
    v_sin_f32 v243, v235
    v_sin_f32 v244, v236
    v_sin_f32 v245, v237
    v_cvt_pk_bf16_f32 v128, v238, v239
    v_cvt_pk_bf16_f32 v129, v240, v241
    v_cvt_pk_bf16_f32 v132, -v242, -v243
    v_cvt_pk_bf16_f32 v133, -v244, -v245
    v_fmamk_f32 v234, v232, 0x40800000, v233
    v_fmamk_f32 v235, v232, 0x40a00000, v233
    v_fmamk_f32 v236, v232, 0x40c00000, v233
    v_fmamk_f32 v237, v232, 0x40e00000, v233
    v_cos_f32 v238, v234
    v_cos_f32 v239, v235
    v_cos_f32 v240, v236
    v_cos_f32 v241, v237
    v_sin_f32 v242, v234
    v_sin_f32 v243, v235
    v_sin_f32 v244, v236
    v_sin_f32 v245, v237
    v_cvt_pk_bf16_f32 v130, v238, v239
    v_cvt_pk_bf16_f32 v131, v240, v241
    v_cvt_pk_bf16_f32 v134, -v242, -v243
    v_cvt_pk_bf16_f32 v135, -v244, -v245
    v_fmamk_f32 v234, v232, 0x42000000, v233
    v_fmamk_f32 v235, v232, 0x42040000, v233
    v_fmamk_f32 v236, v232, 0x42080000, v233
    v_fmamk_f32 v237, v232, 0x420c0000, v233
    v_cos_f32 v238, v234
    v_cos_f32 v239, v235
    v_cos_f32 v240, v236
    v_cos_f32 v241, v237
    v_sin_f32 v242, v234
    v_sin_f32 v243, v235
    v_sin_f32 v244, v236
    v_sin_f32 v245, v237
    v_cvt_pk_bf16_f32 v136, v238, v239
    v_cvt_pk_bf16_f32 v137, v240, v241
    v_cvt_pk_bf16_f32 v140, -v242, -v243
    v_cvt_pk_bf16_f32 v141, -v244, -v245
    v_fmamk_f32 v234, v232, 0x42100000, v233
    v_fmamk_f32 v235, v232, 0x42140000, v233
    v_fmamk_f32 v236, v232, 0x42180000, v233
    v_fmamk_f32 v237, v232, 0x421c0000, v233
    v_cos_f32 v238, v234
    v_cos_f32 v239, v235
    v_cos_f32 v240, v236
    v_cos_f32 v241, v237
    v_sin_f32 v242, v234
    v_sin_f32 v243, v235
    v_sin_f32 v244, v236
    v_sin_f32 v245, v237
    v_cvt_pk_bf16_f32 v138, v238, v239
    v_cvt_pk_bf16_f32 v139, v240, v241
    v_cvt_pk_bf16_f32 v142, -v242, -v243
    v_cvt_pk_bf16_f32 v143, -v244, -v245
    v_mov_b32 v232, 0xbf803f80
    v_cndmask_b32 v132, v132, v232, s[62:63]
    v_cndmask_b32 v133, v133, v232, s[62:63]
    v_cndmask_b32 v134, v134, v232, s[62:63]
    v_cndmask_b32 v135, v135, v232, s[62:63]
    v_cndmask_b32 v140, v140, v232, s[62:63]
    v_cndmask_b32 v141, v141, v232, s[62:63]
    v_cndmask_b32 v142, v142, v232, s[62:63]
    v_cndmask_b32 v143, v143, v232, s[62:63]
    v_and_b32 v232, 1, v1
    v_lshlrev_b32 v232, 4, v232
    v_mov_b32 v233, 0xffff
    v_lshlrev_b32 v232, v232, v233
    v_and_b32 v233, 2, v1
    v_cmp_eq_u32 vcc, 0, v233
    v_lshrrev_b32 v15, 2, v2
    v_cvt_f32_u32 v15, v15
    v_mul_f32 v15, 0x3e000000, v15
    v_cndmask_b32 v7, 0, v232, vcc
    v_xor_b32 v8, v7, v232
    s_mul_i32 s52, s74, 0x3f000000
    v_add_f32 v232, s52, v15
    v_add_f32 v233, 4.0, v10
    v_mul_f32 v234, v232, v10
    v_mul_f32 v235, v232, v233
    v_cos_f32 v236, v234
    v_cos_f32 v237, v235
    v_sin_f32 v238, v234
    v_sin_f32 v239, v235
    v_cvt_pk_bf16_f32 v236, v236, v236
    v_cvt_pk_bf16_f32 v237, v237, v237
    v_cvt_pk_bf16_f32 v234, -v238, -v238
    v_cvt_pk_bf16_f32 v235, -v239, -v239
    v_cvt_pk_bf16_f32 v238, v238, v238
    v_cvt_pk_bf16_f32 v239, v239, v239
    v_and_b32 v144, v236, v7
    v_and_b32 v145, v236, v8
    v_and_b32 v152, v234, v7
    v_and_b32 v153, v234, v8
    v_and_b32 v148, v238, v7
    v_and_b32 v149, v238, v8
    v_and_b32 v146, v237, v7
    v_and_b32 v147, v237, v8
    v_and_b32 v154, v235, v7
    v_and_b32 v155, v235, v8
    v_and_b32 v150, v239, v7
    v_and_b32 v151, v239, v8
    v_lshlrev_b32 v232, 3, v3
    v_bfe_u32 v233, v1, 2, 2
    v_add_u32 v232, v232, v233
    v_mul_u32_u24 v232, 1040, v232
    v_and_b32 v233, 3, v1
    v_lshl_add_u32 v232, v233, 7, v232
    s_lshl_b32 s52, s25, 4
    v_add_u32 v11, s52, v232
    v_lshrrev_b32 v232, 2, v2
    v_and_b32 v233, 2, v3
    v_lshl_add_u32 v232, v232, 3, v233
    s_lshl_b32 s52, s75, 5
    s_lshl_b32 s53, s74, 2
    s_add_u32 s52, s52, s53
    v_add_u32 v232, s52, v232
    v_mul_u32_u24 v232, 32768, v232
    v_and_b32 v233, 3, v2
    v_lshl_add_u32 v232, v233, 5, v232
    v_and_b32 v233, 1, v3
    v_lshl_add_u32 v13, v233, 4, v232
    s_lshl_b32 s52, s24, 3
    s_add_u32 s58, s52, s25
    s_lshl_b32 s52, s58, 7
    s_add_u32 s72, s52, 1048576
    s_add_u32 s73, s72, 32768
    v_cmp_eq_u32 vcc, 0, v3
    s_nop 0
    s_and_b64 s[66:67], vcc, s[62:63]
    s_andn2_b64 s[64:65], s[62:63], vcc
    s_cmp_eq_u32 s74, 0
    s_cselect_b64 s[64:65], 0, s[64:65]
    s_cmp_eq_u32 s24, 0
    s_cselect_b64 s[76:77], -1, 0
    v_lshrrev_b32 v232, 3, v1
    v_and_b32 v234, 7, v1
    v_lshl_add_u32 v233, v234, 3, v232
    s_lshl_b32 s54, s27, 6
    v_add_u32 v233, s54, v233
    v_mul_u32_u24 v192, 8192, v232
    v_lshl_add_u32 v192, v234, 4, v192
    s_lshl_b32 s53, s27, 7
    v_add_u32 v192, s53, v192
    v_cmp_eq_u32 vcc, 0, v233
    v_mov_b32 v239, 1073741824
    s_nop 0
    v_cndmask_b32 v192, v192, v239, vcc
    s_lshl_b32 s52, s24, 1
    s_and_b32 s52, s52, 15
    s_sub_u32 s53, 16, s52
    s_and_b32 s53, s53, 15
    s_add_u32 s52, s52, 0
    s_add_u32 s53, s53, 4736
    v_cmp_lt_u32 vcc, 4, v232
    s_nop 0
    s_and_b64 vcc, vcc, s[76:77]
    v_mov_b32 v235, 8448
    v_cndmask_b32 v236, 0, v235, vcc
    v_lshlrev_b32 v233, 1, v233
    v_add3_u32 v99, v233, s52, v236
    v_sub_u32 v100, s53, v233
    v_add_u32 v100, v100, v236
    v_and_b32 v237, 3, v232
    v_cmp_eq_u32 vcc, 0, v237
    s_nop 0
    s_and_b64 s[78:79], vcc, s[76:77]
    v_add_u32_e64 v237, v99, v235
    v_cndmask_b32 v100, v100, v237, s[78:79]
    v_mov_b32 v96, 0x80000000
    v_cndmask_b32 v96, v96, 0, s[78:79]
    v_bfe_u32 v232, v1, 2, 1
    v_bfe_u32 v233, v1, 3, 1
    v_and_b32_e64 v234, 3, v1
    v_mul_u32_u24 v236, 8448, v232
    v_cndmask_b32 v236, 0, v236, s[76:77]
    v_cndmask_b32 v237, v232, v233, s[76:77]
    v_lshlrev_b32_e64 v237, 9, v237
    v_mul_u32_u24 v238, 528, v234
    v_add3_u32 v236, v236, v237, v238
    v_add_u32 v101, s52, v236
    s_sub_u32 s53, s53, 512
    v_add_u32 v102, s53, v236
    s_mul_i32 s52, s24, 65536
    s_lshl_b32 s53, s25, 10
    s_add_u32 s68, s52, s53
    s_add_u32 s68, s68, 7340032
    v_lshlrev_b32 v236, 9, v232
    v_add_u32 v236, s68, v236
    s_lshl_b32 s53, s25, 4
    s_add_u32 s53, s53, 10485760
    v_lshlrev_b32 v237, 7, v232
    v_add_u32 v237, s53, v237
    v_cmp_eq_u32 vcc, 0, v233
    s_nop 1
    v_cndmask_b32 v193, v237, v236, vcc
    v_lshl_add_u32 v193, v234, 2, v193
    s_cmp_eq_u32 s24, 0
    s_cselect_b32 s53, 16, 8
    v_cmp_gt_u32 vcc, s53, v1
    s_nop 1
    v_cndmask_b32 v193, v239, v193, vcc
    v_bfe_u32 v232, v1, 2, 2
    v_lshlrev_b32 v103, 10, v232
    v_bfe_u32 v232, v1, 1, 1
    v_lshl_add_u32 v103, v232, 7, v103
    v_and_b32_e64 v232, 1, v1
    v_lshl_add_u32 v103, v232, 3, v103
    v_lshl_add_u32 v103, v3, 4, v103
    s_lshl_b32 s52, s27, 8
    v_add_u32 v103, s52, v103
    s_mov_b32 s53, 176128
    v_mul_lo_u32 v194, v3, s53
    v_and_b32_e64 v232, 1, v1
    v_lshl_add_u32 v194, v232, 10, v194
    v_bfe_u32 v232, v1, 1, 3
    v_lshl_add_u32 v194, v232, 4, v194
    s_lshl_b32 s52, s27, 7
    v_add_u32_e64 v194, s52, v194
    s_lshr_b32 s54, s3, 1
    s_lshl_b32 s54, s54, 11
    s_and_b32 s53, s3, 1
    s_lshl_b32 s53, s53, 9
    s_add_u32 s54, s54, s53
    s_add_u32 s44, s54, 11534336
    s_add_u32 s45, s44, 704512
    s_cmp_eq_u32 s24, 0
    s_cselect_b32 s52, 1, 0
    s_and_b32 s53, s25, 3
    s_cmp_eq_u32 s53, 0
    s_cselect_b32 s61, s52, 0
    s_cmp_gt_u32 s25, 4
    s_cselect_b32 s53, s52, 0
    s_mul_i32 s60, s53, 0x3e800000
    s_lshr_b32 s54, s27, 1
    s_and_b32 s54, s54, s61
    s_or_b32 s53, s53, s54
    s_lshl_b32 s53, s53, 5
    s_add_u32 s59, s24, s53
    s_waitcnt lgkmcnt(0)
    s_mul_i32 s56, s56, 0x9e3779b1
    s_add_u32 s56, s56, 0x7f4a7c15
    s_mul_i32 s57, s57, 0x85ebca6b
    s_add_u32 s57, s57, 0xc2b2ae35
    s_setprio 2
spin4_14:
    ds_read_b32 v200, v4 offset:0
    s_waitcnt lgkmcnt(0)
    v_cmp_ne_u32 vcc, 16843009, v200
    s_cbranch_vccnz spin4_14
    ds_read_b64_tr_b16 v[200:201], v11 offset:18304
    ds_read_b64_tr_b16 v[202:203], v11 offset:22464
    ds_read_b64_tr_b16 v[204:205], v11 offset:18816
    ds_read_b64_tr_b16 v[206:207], v11 offset:22976
    ds_read_b64_tr_b16 v[208:209], v11 offset:51584
    ds_read_b64_tr_b16 v[210:211], v11 offset:55744
    ds_read_b64_tr_b16 v[212:213], v11 offset:52096
    ds_read_b64_tr_b16 v[214:215], v11 offset:56256
    ds_read_b64_tr_b16 v[216:217], v11 offset:18312
    ds_read_b64_tr_b16 v[218:219], v11 offset:22472
    ds_read_b64_tr_b16 v[220:221], v11 offset:18824
    ds_read_b64_tr_b16 v[222:223], v11 offset:22984
    ds_read_b64_tr_b16 v[224:225], v11 offset:51592
    ds_read_b64_tr_b16 v[226:227], v11 offset:55752
    ds_read_b64_tr_b16 v[228:229], v11 offset:52104
    ds_read_b64_tr_b16 v[230:231], v11 offset:56264
    s_waitcnt lgkmcnt(14)
    v_mfma_f32_16x16x32_bf16 v[16:19], v[200:203], v[128:131], 0
    v_mfma_f32_16x16x32_bf16 v[24:27], v[200:203], v[132:135], 0
    s_waitcnt lgkmcnt(12)
    v_mfma_f32_16x16x32_bf16 v[20:23], v[204:207], v[128:131], 0
    v_mfma_f32_16x16x32_bf16 v[28:31], v[204:207], v[132:135], 0
    s_waitcnt lgkmcnt(10)
    v_mfma_f32_16x16x32_bf16 v[16:19], v[208:211], v[136:139], v[16:19]
    v_mfma_f32_16x16x32_bf16 v[24:27], v[208:211], v[140:143], v[24:27]
    s_waitcnt lgkmcnt(8)
    v_mfma_f32_16x16x32_bf16 v[20:23], v[212:215], v[136:139], v[20:23]
    v_mfma_f32_16x16x32_bf16 v[28:31], v[212:215], v[140:143], v[28:31]
    s_waitcnt lgkmcnt(6)
    v_mfma_f32_16x16x32_bf16 v[32:35], v[216:219], v[128:131], 0
    v_mfma_f32_16x16x32_bf16 v[40:43], v[216:219], v[132:135], 0
    s_waitcnt lgkmcnt(4)
    v_mfma_f32_16x16x32_bf16 v[36:39], v[220:223], v[128:131], 0
    v_mfma_f32_16x16x32_bf16 v[44:47], v[220:223], v[132:135], 0
    s_waitcnt lgkmcnt(2)
    v_mfma_f32_16x16x32_bf16 v[32:35], v[224:227], v[136:139], v[32:35]
    v_mfma_f32_16x16x32_bf16 v[40:43], v[224:227], v[140:143], v[40:43]
    s_waitcnt lgkmcnt(0)
    v_mfma_f32_16x16x32_bf16 v[36:39], v[228:231], v[136:139], v[36:39]
    v_mfma_f32_16x16x32_bf16 v[44:47], v[228:231], v[140:143], v[44:47]
    v_cvt_pk_bf16_f32 v48, v16, v17
    v_cvt_pk_bf16_f32 v49, v18, v19
    v_cvt_pk_bf16_f32 v50, v20, v21
    v_cvt_pk_bf16_f32 v51, v22, v23
    v_cvt_pk_bf16_f32 v52, v24, v25
    v_cvt_pk_bf16_f32 v53, v26, v27
    v_cvt_pk_bf16_f32 v54, v28, v29
    v_cvt_pk_bf16_f32 v55, v30, v31
    v_cndmask_b32 v64, v52, 0, s[62:63]
    v_cndmask_b32 v65, v53, 0, s[62:63]
    v_cndmask_b32 v66, v54, 0, s[62:63]
    v_cndmask_b32 v67, v55, 0, s[62:63]
    v_mfma_f32_16x16x32_bf16 v[232:235], v[144:147], v[48:51], 0
    v_mfma_f32_16x16x32_bf16 v[236:239], v[152:155], v[48:51], 0
    v_mfma_f32_16x16x32_bf16 v[200:203], v[144:147], v[52:55], 0
    v_mfma_f32_16x16x32_bf16 v[204:207], v[152:155], v[52:55], 0
    v_mfma_f32_16x16x32_bf16 v[232:235], v[148:151], v[64:67], v[232:235]
    v_mfma_f32_16x16x32_bf16 v[236:239], v[144:147], v[64:67], v[236:239]
    v_cvt_pk_bf16_f32 v56, v32, v33
    v_cvt_pk_bf16_f32 v57, v34, v35
    v_cvt_pk_bf16_f32 v58, v36, v37
    v_cvt_pk_bf16_f32 v59, v38, v39
    v_cvt_pk_bf16_f32 v60, v40, v41
    v_cvt_pk_bf16_f32 v61, v42, v43
    v_cvt_pk_bf16_f32 v62, v44, v45
    v_cvt_pk_bf16_f32 v63, v46, v47
    v_cndmask_b32 v68, v60, 0, s[62:63]
    v_cndmask_b32 v69, v61, 0, s[62:63]
    v_cndmask_b32 v70, v62, 0, s[62:63]
    v_cndmask_b32 v71, v63, 0, s[62:63]
    v_mfma_f32_16x16x32_bf16 v[240:243], v[144:147], v[56:59], 0
    v_mfma_f32_16x16x32_bf16 v[244:247], v[152:155], v[56:59], 0
    v_mfma_f32_16x16x32_bf16 v[208:211], v[144:147], v[60:63], 0
    v_mfma_f32_16x16x32_bf16 v[212:215], v[152:155], v[60:63], 0
    v_mfma_f32_16x16x32_bf16 v[240:243], v[148:151], v[68:71], v[240:243]
    v_mfma_f32_16x16x32_bf16 v[244:247], v[144:147], v[68:71], v[244:247]
    v_cvt_pk_bf16_f32 v248, v200, v201
    v_cvt_pk_bf16_f32 v249, v202, v203
    v_cvt_pk_bf16_f32 v250, v204, v205
    v_cvt_pk_bf16_f32 v251, v206, v207
    v_cvt_pk_bf16_f32 v216, v232, v233
    v_cvt_pk_bf16_f32 v217, v234, v235
    v_cvt_pk_bf16_f32 v218, v236, v237
    v_cvt_pk_bf16_f32 v219, v238, v239
    v_cndmask_b32 v218, v218, v248, s[66:67]
    v_cndmask_b32 v219, v219, v249, s[66:67]
    v_cndmask_b32 v216, v216, v248, s[64:65]
    v_cndmask_b32 v217, v217, v249, s[64:65]
    v_cndmask_b32 v218, v218, v250, s[64:65]
    v_cndmask_b32 v219, v219, v251, s[64:65]
    v_or_b32 v216, 1, v216
    v_or_b32 v217, 1, v217
    v_or_b32 v218, 1, v218
    v_or_b32 v219, 1, v219
    v_cvt_pk_bf16_f32 v252, v208, v209
    v_cvt_pk_bf16_f32 v253, v210, v211
    v_cvt_pk_bf16_f32 v254, v212, v213
    v_cvt_pk_bf16_f32 v255, v214, v215
    v_cvt_pk_bf16_f32 v220, v240, v241
    v_cvt_pk_bf16_f32 v221, v242, v243
    v_cvt_pk_bf16_f32 v222, v244, v245
    v_cvt_pk_bf16_f32 v223, v246, v247
    v_cndmask_b32 v222, v222, v252, s[66:67]
    v_cndmask_b32 v223, v223, v253, s[66:67]
    v_cndmask_b32 v220, v220, v252, s[64:65]
    v_cndmask_b32 v221, v221, v253, s[64:65]
    v_cndmask_b32 v222, v222, v254, s[64:65]
    v_cndmask_b32 v223, v223, v255, s[64:65]
    v_or_b32 v220, 1, v220
    v_or_b32 v221, 1, v221
    v_or_b32 v222, 1, v222
    v_or_b32 v223, 1, v223
    v_permlane16_swap_b32 v216, v220
    v_permlane16_swap_b32 v217, v221
    v_permlane16_swap_b32 v218, v222
    v_permlane16_swap_b32 v219, v223
    buffer_store_dwordx4 v[216:219], v13, s[32:35], s72 offen sc1
    buffer_store_dwordx4 v[220:223], v13, s[32:35], s73 offen sc1
    s_branch spin_16
spin4_15:
    s_sleep 1
spin_16:
    ds_read_b32 v200, v4 offset:16
    s_waitcnt lgkmcnt(0)
    v_cmp_ne_u32 vcc, 16843009, v200
    s_cbranch_vccnz spin4_15
    ds_read_u16 v72, v99 offset:0
    ds_read_u16 v73, v99 offset:528
    ds_read_u16 v74, v99 offset:1056
    ds_read_u16 v75, v99 offset:1584
    ds_read_u16 v76, v99 offset:2112
    ds_read_u16 v77, v99 offset:2640
    ds_read_u16 v78, v99 offset:3168
    ds_read_u16 v79, v99 offset:3696
    ds_read_b64_tr_b16 v[168:169], v103 offset:8704
    ds_read_b64_tr_b16 v[170:171], v103 offset:12800
    ds_read_b64_tr_b16 v[172:173], v103 offset:8768
    ds_read_b64_tr_b16 v[174:175], v103 offset:12864
    ds_read_u16 v80, v100 offset:0
    ds_read_u16 v81, v100 offset:528
    ds_read_u16 v82, v100 offset:1056
    ds_read_u16 v83, v100 offset:1584
    ds_read_u16 v84, v100 offset:2112
    ds_read_u16 v85, v100 offset:2640
    ds_read_u16 v86, v100 offset:3168
    ds_read_u16 v87, v100 offset:3696
    s_waitcnt lgkmcnt(15)
    v_lshl_or_b32 v176, v76, 16, v72
    s_waitcnt lgkmcnt(14)
    v_lshl_or_b32 v177, v77, 16, v73
    s_waitcnt lgkmcnt(13)
    v_lshl_or_b32 v178, v78, 16, v74
    s_waitcnt lgkmcnt(12)
    v_lshl_or_b32 v179, v79, 16, v75
    ds_read_u16 v188, v101
    ds_read_u16 v189, v101 offset:2112
    ds_read_u16 v190, v102
    ds_read_u16 v191, v102 offset:2112
    s_waitcnt lgkmcnt(7)
    v_lshl_or_b32 v180, v84, 16, v80
    v_xor_b32 v180, v180, v96
    s_waitcnt lgkmcnt(6)
    v_lshl_or_b32 v181, v85, 16, v81
    v_xor_b32 v181, v181, v96
    s_waitcnt lgkmcnt(5)
    v_lshl_or_b32 v182, v86, 16, v82
    v_xor_b32 v182, v182, v96
    s_waitcnt lgkmcnt(4)
    v_lshl_or_b32 v183, v87, 16, v83
    v_xor_b32 v183, v183, v96
    s_waitcnt lgkmcnt(3)
    v_lshlrev_b32 v188, 16, v188
    s_waitcnt lgkmcnt(2)
    v_lshlrev_b32 v189, 16, v189
    s_waitcnt lgkmcnt(1)
    v_lshlrev_b32 v190, 16, v190
    s_waitcnt lgkmcnt(0)
    v_lshlrev_b32 v191, 16, v191
    v_add_f32 v188, v188, v190
    v_sub_f32 v189, v189, v191
    v_mul_f32_e64 v188, 0.5, v188
    v_mul_f32 v189, 0.5, v189
    v_cvt_pk_bf16_f32 v188, v188, v189
    s_cmp_ge_u32 s3, 172
    s_cbranch_scc1 skip_17
    buffer_store_dwordx4 v[168:171], v194, s[32:35], s44 offen sc1
    buffer_store_dwordx4 v[172:175], v194, s[32:35], s45 offen sc1
skip_17:
    buffer_store_dwordx4 v[176:179], v192, s[32:35], s68 offen sc1
    buffer_store_dwordx4 v[180:183], v192, s[32:35], s68 offen offset:512 sc1
    s_cmp_lg_u32 s27, 3
    s_cbranch_scc1 skip_18
    buffer_store_dword v188, v193, s[32:35], 0 offen sc1
skip_18:
    s_lshl_b32 s52, s61, 1
    s_andn2_b32 s52, s27, s52
    s_lshl_b32 s52, s52, 7
    s_add_u32 s52, s52, s25
    v_lshlrev_b32 v200, 3, v2
    v_add_u32 v200, s52, v200
    v_cvt_f32_u32 v200, v200
    v_mul_f32 v200, 0x3b000000, v200
    v_mul_f32 v201, 4.0, v10
    v_mul_f32_e64 v201, v201, v200
    v_fmamk_f32 v203, v200, 0x3f800000, v201
    v_fmamk_f32 v204, v200, 0x40000000, v201
    v_fmamk_f32 v205, v200, 0x40400000, v201
    v_cos_f32 v206, v201
    v_cos_f32 v207, v203
    v_cos_f32 v208, v204
    v_cos_f32 v209, v205
    v_sin_f32 v210, v201
    v_sin_f32 v211, v203
    v_sin_f32 v212, v204
    v_sin_f32 v213, v205
    v_cvt_pk_bf16_f32 v16, v206, v207
    v_cvt_pk_bf16_f32 v22, v206, v207
    v_cvt_pk_bf16_f32 v17, v208, v209
    v_cvt_pk_bf16_f32 v23, v208, v209
    v_cvt_pk_bf16_f32 v18, v210, v211
    v_cvt_pk_bf16_f32 v20, -v210, -v211
    v_cvt_pk_bf16_f32 v19, v212, v213
    v_cvt_pk_bf16_f32 v21, -v212, -v213
    v_fmamk_f32 v202, v200, 0x41800000, v201
    v_fmamk_f32 v203, v200, 0x41880000, v201
    v_fmamk_f32 v204, v200, 0x41900000, v201
    v_fmamk_f32 v205, v200, 0x41980000, v201
    v_cos_f32 v206, v202
    v_cos_f32 v207, v203
    v_cos_f32 v208, v204
    v_cos_f32 v209, v205
    v_sin_f32 v210, v202
    v_sin_f32 v211, v203
    v_sin_f32 v212, v204
    v_sin_f32 v213, v205
    v_cvt_pk_bf16_f32 v24, v206, v207
    v_cvt_pk_bf16_f32 v30, v206, v207
    v_cvt_pk_bf16_f32 v25, v208, v209
    v_cvt_pk_bf16_f32 v31, v208, v209
    v_cvt_pk_bf16_f32 v26, v210, v211
    v_cvt_pk_bf16_f32 v28, -v210, -v211
    v_cvt_pk_bf16_f32 v27, v212, v213
    v_cvt_pk_bf16_f32 v29, -v212, -v213
    v_fmamk_f32 v202, v200, 0x42000000, v201
    v_fmamk_f32 v203, v200, 0x42040000, v201
    v_fmamk_f32 v204, v200, 0x42080000, v201
    v_fmamk_f32 v205, v200, 0x420c0000, v201
    v_cos_f32 v206, v202
    v_cos_f32 v207, v203
    v_cos_f32 v208, v204
    v_cos_f32 v209, v205
    v_sin_f32 v210, v202
    v_sin_f32 v211, v203
    v_sin_f32 v212, v204
    v_sin_f32 v213, v205
    v_cvt_pk_bf16_f32 v32, v206, v207
    v_cvt_pk_bf16_f32 v38, v206, v207
    v_cvt_pk_bf16_f32 v33, v208, v209
    v_cvt_pk_bf16_f32 v39, v208, v209
    v_cvt_pk_bf16_f32 v34, v210, v211
    v_cvt_pk_bf16_f32 v36, -v210, -v211
    v_cvt_pk_bf16_f32 v35, v212, v213
    v_cvt_pk_bf16_f32 v37, -v212, -v213
    v_fmamk_f32 v202, v200, 0x42400000, v201
    v_fmamk_f32 v203, v200, 0x42440000, v201
    v_fmamk_f32 v204, v200, 0x42480000, v201
    v_fmamk_f32 v205, v200, 0x424c0000, v201
    v_cos_f32 v206, v202
    v_cos_f32 v207, v203
    v_cos_f32 v208, v204
    v_cos_f32 v209, v205
    v_sin_f32 v210, v202
    v_sin_f32 v211, v203
    v_sin_f32 v212, v204
    v_sin_f32 v213, v205
    v_cvt_pk_bf16_f32 v40, v206, v207
    v_cvt_pk_bf16_f32 v46, v206, v207
    v_cvt_pk_bf16_f32 v41, v208, v209
    v_cvt_pk_bf16_f32 v47, v208, v209
    v_cvt_pk_bf16_f32 v42, v210, v211
    v_cvt_pk_bf16_f32 v44, -v210, -v211
    v_cvt_pk_bf16_f32 v43, v212, v213
    v_cvt_pk_bf16_f32 v45, -v212, -v213
    v_mov_b32 v232, s56
    v_mov_b32 v233, s57
    v_lshlrev_b32_e64 v234, 3, v1
    s_mul_i32 s52, s2, 64
    s_add_u32 s52, s52, 131072
    s_waitcnt vmcnt(0)
    s_mov_b64 exec, 1
    ds_add_rtn_u32 v235, v4, v5 offset:96
    s_waitcnt lgkmcnt(0)
    v_readfirstlane_b32 s53, v235
    s_nop 0
    s_cmp_lg_u32 s53, 3
    s_cbranch_scc1 skip_19
    s_mov_b64 exec, 255
    buffer_store_dwordx2 v[232:233], v234, s[32:35], s52 offen sc1
skip_19:
    s_mov_b64 exec, -1
    v_lshlrev_b32 v200, 6, v2
    s_add_u32 s52, s59, 0
    v_add_u32 v200, s52, v200
    v_cvt_f32_u32 v200, v200
    v_mul_f32 v200, 0x3a000000, v200
    v_mul_f32 v201, 4.0, v10
    v_mul_f32_e64 v201, v201, v200
    v_fmamk_f32 v203, v200, 0x3f800000, v201
    v_fmamk_f32 v204, v200, 0x40000000, v201
    v_fmamk_f32 v205, v200, 0x40400000, v201
    v_cos_f32 v206, v201
    v_cos_f32 v207, v203
    v_cos_f32 v208, v204
    v_cos_f32 v209, v205
    v_sin_f32 v210, v201
    v_sin_f32 v211, v203
    v_sin_f32 v212, v204
    v_sin_f32 v213, v205
    v_cvt_pk_bf16_f32 v48, v206, v207
    v_cvt_pk_bf16_f32 v49, v208, v209
    v_cvt_pk_bf16_f32 v52, v210, v211
    v_cvt_pk_bf16_f32 v56, -v210, -v211
    v_cvt_pk_bf16_f32 v53, v212, v213
    v_cvt_pk_bf16_f32 v57, -v212, -v213
    v_fmamk_f32 v202, v200, 0x41800000, v201
    v_fmamk_f32 v203, v200, 0x41880000, v201
    v_fmamk_f32 v204, v200, 0x41900000, v201
    v_fmamk_f32 v205, v200, 0x41980000, v201
    v_cos_f32 v206, v202
    v_cos_f32 v207, v203
    v_cos_f32 v208, v204
    v_cos_f32 v209, v205
    v_sin_f32 v210, v202
    v_sin_f32 v211, v203
    v_sin_f32 v212, v204
    v_sin_f32 v213, v205
    v_cvt_pk_bf16_f32 v50, v206, v207
    v_cvt_pk_bf16_f32 v51, v208, v209
    v_cvt_pk_bf16_f32 v54, v210, v211
    v_cvt_pk_bf16_f32 v58, -v210, -v211
    v_cvt_pk_bf16_f32 v55, v212, v213
    v_cvt_pk_bf16_f32 v59, -v212, -v213
    v_lshlrev_b32 v200, 6, v2
    s_add_u32 s52, s59, 1024
    v_add_u32 v200, s52, v200
    v_cvt_f32_u32 v200, v200
    v_mul_f32 v200, 0x3a000000, v200
    v_mul_f32 v201, 4.0, v10
    v_mul_f32_e64 v201, v201, v200
    v_fmamk_f32 v203, v200, 0x3f800000, v201
    v_fmamk_f32 v204, v200, 0x40000000, v201
    v_fmamk_f32 v205, v200, 0x40400000, v201
    v_cos_f32 v206, v201
    v_cos_f32 v207, v203
    v_cos_f32 v208, v204
    v_cos_f32 v209, v205
    v_sin_f32 v210, v201
    v_sin_f32 v211, v203
    v_sin_f32 v212, v204
    v_sin_f32 v213, v205
    v_cvt_pk_bf16_f32 v60, v206, v207
    v_cvt_pk_bf16_f32 v61, v208, v209
    v_cvt_pk_bf16_f32 v64, v210, v211
    v_cvt_pk_bf16_f32 v68, -v210, -v211
    v_cvt_pk_bf16_f32 v65, v212, v213
    v_cvt_pk_bf16_f32 v69, -v212, -v213
    v_fmamk_f32 v202, v200, 0x41800000, v201
    v_fmamk_f32 v203, v200, 0x41880000, v201
    v_fmamk_f32 v204, v200, 0x41900000, v201
    v_fmamk_f32 v205, v200, 0x41980000, v201
    v_cos_f32 v206, v202
    v_cos_f32 v207, v203
    v_cos_f32 v208, v204
    v_cos_f32 v209, v205
    v_sin_f32 v210, v202
    v_sin_f32 v211, v203
    v_sin_f32 v212, v204
    v_sin_f32 v213, v205
    v_cvt_pk_bf16_f32 v62, v206, v207
    v_cvt_pk_bf16_f32 v63, v208, v209
    v_cvt_pk_bf16_f32 v66, v210, v211
    v_cvt_pk_bf16_f32 v70, -v210, -v211
    v_cvt_pk_bf16_f32 v67, v212, v213
    v_cvt_pk_bf16_f32 v71, -v212, -v213
    v_lshlrev_b32 v214, 8, v3
    v_add_u32 v214, s59, v214
    v_cvt_f32_u32 v214, v214
    v_mul_f32 v214, 0x3c800000, v214
    v_add_f32 v200, 0x00000000, v9
    v_mul_f32 v200, 0x3d000000, v200
    v_fma_f32 v201, v200, v214, s60
    v_fmamk_f32 v203, v200, 0x3f800000, v201
    v_fmamk_f32 v204, v200, 0x40000000, v201
    v_fmamk_f32 v205, v200, 0x40400000, v201
    v_cos_f32 v206, v201
    v_cos_f32 v207, v203
    v_cos_f32 v208, v204
    v_cos_f32 v209, v205
    v_sin_f32 v210, v201
    v_sin_f32 v211, v203
    v_sin_f32 v212, v204
    v_sin_f32 v213, v205
    v_cvt_pk_bf16_f32 v72, v206, v207
    v_cvt_pk_bf16_f32 v73, v208, v209
    v_cvt_pk_bf16_f32 v76, v210, v211
    v_cvt_pk_bf16_f32 v80, -v210, -v211
    v_cvt_pk_bf16_f32 v77, v212, v213
    v_cvt_pk_bf16_f32 v81, -v212, -v213
    v_fmamk_f32 v202, v200, 0x41800000, v201
    v_fmamk_f32 v203, v200, 0x41880000, v201
    v_fmamk_f32 v204, v200, 0x41900000, v201
    v_fmamk_f32 v205, v200, 0x41980000, v201
    v_cos_f32 v206, v202
    v_cos_f32 v207, v203
    v_cos_f32 v208, v204
    v_cos_f32 v209, v205
    v_sin_f32 v210, v202
    v_sin_f32 v211, v203
    v_sin_f32 v212, v204
    v_sin_f32 v213, v205
    v_cvt_pk_bf16_f32 v74, v206, v207
    v_cvt_pk_bf16_f32 v75, v208, v209
    v_cvt_pk_bf16_f32 v78, v210, v211
    v_cvt_pk_bf16_f32 v82, -v210, -v211
    v_cvt_pk_bf16_f32 v79, v212, v213
    v_cvt_pk_bf16_f32 v83, -v212, -v213
    v_add_f32 v200, 0x41800000, v9
    v_mul_f32 v200, 0x3d000000, v200
    v_fma_f32 v201, v200, v214, s60
    v_fmamk_f32 v203, v200, 0x3f800000, v201
    v_fmamk_f32 v204, v200, 0x40000000, v201
    v_fmamk_f32 v205, v200, 0x40400000, v201
    v_cos_f32 v206, v201
    v_cos_f32 v207, v203
    v_cos_f32 v208, v204
    v_cos_f32 v209, v205
    v_sin_f32 v210, v201
    v_sin_f32 v211, v203
    v_sin_f32 v212, v204
    v_sin_f32 v213, v205
    v_cvt_pk_bf16_f32 v84, v206, v207
    v_cvt_pk_bf16_f32 v85, v208, v209
    v_cvt_pk_bf16_f32 v88, v210, v211
    v_cvt_pk_bf16_f32 v92, -v210, -v211
    v_cvt_pk_bf16_f32 v89, v212, v213
    v_cvt_pk_bf16_f32 v93, -v212, -v213
    v_fmamk_f32 v202, v200, 0x41800000, v201
    v_fmamk_f32 v203, v200, 0x41880000, v201
    v_fmamk_f32 v204, v200, 0x41900000, v201
    v_fmamk_f32 v205, v200, 0x41980000, v201
    v_cos_f32 v206, v202
    v_cos_f32 v207, v203
    v_cos_f32 v208, v204
    v_cos_f32 v209, v205
    v_sin_f32 v210, v202
    v_sin_f32 v211, v203
    v_sin_f32 v212, v204
    v_sin_f32 v213, v205
    v_cvt_pk_bf16_f32 v86, v206, v207
    v_cvt_pk_bf16_f32 v87, v208, v209
    v_cvt_pk_bf16_f32 v90, v210, v211
    v_cvt_pk_bf16_f32 v94, -v210, -v211
    v_cvt_pk_bf16_f32 v91, v212, v213
    v_cvt_pk_bf16_f32 v95, -v212, -v213
    v_lshrrev_b32 v6, 1, v3
    v_lshlrev_b32 v6, 7, v6
    v_lshl_add_u32 v6, v2, 10, v6
    v_and_b32_e64 v13, 1, v3
    v_lshl_add_u32 v6, v13, 4, v6
    s_lshr_b32 s52, s24, 2
    s_lshl_b32 s52, s52, 3
    s_add_u32 s52, s52, s25
    s_mul_i32 s52, s52, 32768
    s_and_b32 s53, s24, 3
    s_lshl_b32 s53, s53, 5
    s_add_u32 s52, s52, s53
    s_lshl_b32 s53, s27, 8
    s_add_u32 s52, s52, s53
    s_add_u32 s70, s52, 1048576
    s_add_u32 s71, s70, 16384
    v_lshlrev_b32 v11, 10, v3
    v_lshl_add_u32 v11, v2, 4, v11
    s_mul_i32 s52, s58, 8192
    s_add_u32 s52, s52, s53
    s_add_u32 s74, s52, 7340032
    s_add_u32 s75, s74, 4096
    s_branch spin_21
spin4_20:
    s_sleep 1
spin_21:
    ds_read_b32 v204, v4 offset:28
    s_waitcnt lgkmcnt(0)
    v_cmp_ne_u32 vcc, 16843009, v204
    s_cbranch_vccnz spin4_20
    s_mul_i32 s52, s27, 4096
    s_add_u32 s52, s52, 131072
    s_mov_b32 s53, 0
    v_mul_u32_u24 v202, 64, v1
poll_23:
    buffer_load_dwordx2 v[200:201], v202, s[32:35], s52 offen sc1
    s_waitcnt vmcnt(0)
    v_xor_b32 v200, s56, v200
    v_xor_b32 v201, s57, v201
    v_or_b32 v200, v200, v201
    v_cmp_ne_u32 vcc, 0, v200
    s_cbranch_vccz go_22
    s_sleep 8
    s_add_u32 s53, s53, 1
    s_cmp_lt_u32 s53, 200000
    s_cbranch_scc1 poll_23
go_22:
    s_mov_b64 exec, 1
    ds_add_u32 v4, v5 offset:72
    s_mov_b64 exec, -1
    s_waitcnt lgkmcnt(0)
spin_24:
    ds_read_b32 v203, v4 offset:72
    s_waitcnt lgkmcnt(0)
    v_readfirstlane_b32 s55, v203
    s_nop 0
    s_cmp_lt_u32 s55, 4
    s_cbranch_scc1 spin_24
    s_lshl_b32 s52, s27, 11
    s_add_u32 m0, s52, 0
    s_nop 0
    buffer_load_dwordx4 v6, s[32:35], s70 offen sc1 lds
    s_lshl_b32 s52, s27, 11
    s_add_u32 m0, s52, 1024
    s_nop 0
    buffer_load_dwordx4 v6, s[32:35], s71 offen sc1 lds
    buffer_load_dwordx4 v[128:131], v11, s[32:35], s74 offen sc1
    buffer_load_dwordx4 v[132:135], v11, s[32:35], s75 offen sc1
    s_cmp_lg_u32 s58, 0
    s_cbranch_scc1 skip_25
    v_lshlrev_b32_e64 v11, 4, v3
    s_lshr_b32 s52, s27, 1
    s_lshl_b32 s52, s52, 7
    s_add_u32 s52, s52, 10485760
    buffer_load_dwordx4 v[168:171], v11, s[32:35], s52 offen offset:0 sc1
    buffer_load_dwordx4 v[172:175], v11, s[32:35], s52 offen offset:64 sc1
skip_25:
    s_lshl_b32 s52, s27, 4
    v_add_u32 v200, s52, v2
    v_cvt_f32_u32 v200, v200
    v_mul_f32 v200, 0x3c800000, v200
    v_lshlrev_b32 v201, 5, v3
    v_add_u32 v201, s25, v201
    v_cvt_f32_u32 v201, v201
    v_mul_f32 v201, 0x3e000000, v201
    v_mul_f32_e64 v201, v201, v200
    v_fmamk_f32 v203, v200, 0x3f800000, v201
    v_fmamk_f32 v204, v200, 0x40000000, v201
    v_fmamk_f32 v205, v200, 0x40400000, v201
    v_cos_f32 v206, v201
    v_cos_f32 v207, v203
    v_cos_f32 v208, v204
    v_cos_f32 v209, v205
    v_sin_f32 v210, v201
    v_sin_f32 v211, v203
    v_sin_f32 v212, v204
    v_sin_f32 v213, v205
    v_cvt_pk_bf16_f32 v96, v206, v207
    v_cvt_pk_bf16_f32 v102, v206, v207
    v_cvt_pk_bf16_f32 v97, v208, v209
    v_cvt_pk_bf16_f32 v103, v208, v209
    v_cvt_pk_bf16_f32 v98, -v210, -v211
    v_cvt_pk_bf16_f32 v100, v210, v211
    v_cvt_pk_bf16_f32 v99, -v212, -v213
    v_cvt_pk_bf16_f32 v101, v212, v213
    v_fmamk_f32 v202, v200, 0x41800000, v201
    v_fmamk_f32 v203, v200, 0x41880000, v201
    v_fmamk_f32 v204, v200, 0x41900000, v201
    v_fmamk_f32 v205, v200, 0x41980000, v201
    v_cos_f32 v206, v202
    v_cos_f32 v207, v203
    v_cos_f32 v208, v204
    v_cos_f32 v209, v205
    v_sin_f32 v210, v202
    v_sin_f32 v211, v203
    v_sin_f32 v212, v204
    v_sin_f32 v213, v205
    v_cvt_pk_bf16_f32 v104, v206, v207
    v_cvt_pk_bf16_f32 v110, v206, v207
    v_cvt_pk_bf16_f32 v105, v208, v209
    v_cvt_pk_bf16_f32 v111, v208, v209
    v_cvt_pk_bf16_f32 v106, -v210, -v211
    v_cvt_pk_bf16_f32 v108, v210, v211
    v_cvt_pk_bf16_f32 v107, -v212, -v213
    v_cvt_pk_bf16_f32 v109, v212, v213
    v_fmamk_f32 v202, v200, 0x42000000, v201
    v_fmamk_f32 v203, v200, 0x42040000, v201
    v_fmamk_f32 v204, v200, 0x42080000, v201
    v_fmamk_f32 v205, v200, 0x420c0000, v201
    v_cos_f32 v206, v202
    v_cos_f32 v207, v203
    v_cos_f32 v208, v204
    v_cos_f32 v209, v205
    v_sin_f32 v210, v202
    v_sin_f32 v211, v203
    v_sin_f32 v212, v204
    v_sin_f32 v213, v205
    v_cvt_pk_bf16_f32 v112, v206, v207
    v_cvt_pk_bf16_f32 v118, v206, v207
    v_cvt_pk_bf16_f32 v113, v208, v209
    v_cvt_pk_bf16_f32 v119, v208, v209
    v_cvt_pk_bf16_f32 v114, -v210, -v211
    v_cvt_pk_bf16_f32 v116, v210, v211
    v_cvt_pk_bf16_f32 v115, -v212, -v213
    v_cvt_pk_bf16_f32 v117, v212, v213
    v_fmamk_f32 v202, v200, 0x42400000, v201
    v_fmamk_f32 v203, v200, 0x42440000, v201
    v_fmamk_f32 v204, v200, 0x42480000, v201
    v_fmamk_f32 v205, v200, 0x424c0000, v201
    v_cos_f32 v206, v202
    v_cos_f32 v207, v203
    v_cos_f32 v208, v204
    v_cos_f32 v209, v205
    v_sin_f32 v210, v202
    v_sin_f32 v211, v203
    v_sin_f32 v212, v204
    v_sin_f32 v213, v205
    v_cvt_pk_bf16_f32 v120, v206, v207
    v_cvt_pk_bf16_f32 v126, v206, v207
    v_cvt_pk_bf16_f32 v121, v208, v209
    v_cvt_pk_bf16_f32 v127, v208, v209
    v_cvt_pk_bf16_f32 v122, -v210, -v211
    v_cvt_pk_bf16_f32 v124, v210, v211
    v_cvt_pk_bf16_f32 v123, -v212, -v213
    v_cvt_pk_bf16_f32 v125, v212, v213
    s_waitcnt vmcnt(2)
    s_mov_b64 exec, 1
    ds_add_u32 v4, v5 offset:76
    s_mov_b64 exec, -1
    s_cmp_eq_u32 s61, 0
    s_cbranch_scc1 skip_26
    s_cmp_lg_u32 s25, 0
    s_cbranch_scc1 skip_27
    s_and_b32 s52, s27, 1
    v_or_b32 v204, s52, v2
    v_cmp_eq_u32 vcc, 0, v204
    v_mov_b32 v204, 0xbf803f80
    s_nop 0
    v_cndmask_b32 v20, v20, v204, vcc
    v_cndmask_b32 v21, v21, v204, vcc
    v_cndmask_b32 v28, v28, v204, vcc
    v_cndmask_b32 v29, v29, v204, vcc
    v_cndmask_b32 v36, v36, v204, vcc
    v_cndmask_b32 v37, v37, v204, vcc
    v_cndmask_b32 v44, v44, v204, vcc
    v_cndmask_b32 v45, v45, v204, vcc
    v_cmp_eq_u32 vcc, 0, v3
    v_mov_b32 v206, 0xffff
    v_mov_b32 v204, 0x3f00
    v_bfi_b32 v204, v206, v204, v96
    v_cndmask_b32 v96, v96, v204, vcc
    v_and_b32 v204, 1, v2
    v_lshlrev_b32_e64 v204, 15, v204
    v_or_b32 v204, 0x3f00, v204
    v_bfi_b32 v204, v206, v204, v98
    v_cndmask_b32 v98, v98, v204, vcc
skip_27:
    v_mov_b32 v116, v96
    v_mov_b32 v112, 0
    v_mov_b32 v100, 0
    v_mov_b32 v117, v97
    v_mov_b32 v113, 0
    v_mov_b32 v101, 0
    v_mov_b32 v118, v98
    v_mov_b32 v114, 0
    v_mov_b32 v102, 0
    v_mov_b32 v119, v99
    v_mov_b32 v115, 0
    v_mov_b32 v103, 0
    v_mov_b32 v124, v104
    v_mov_b32 v120, 0
    v_mov_b32 v108, 0
    v_mov_b32 v125, v105
    v_mov_b32 v121, 0
    v_mov_b32 v109, 0
    v_mov_b32 v126, v106
    v_mov_b32 v122, 0
    v_mov_b32 v110, 0
    v_mov_b32 v127, v107
    v_mov_b32 v123, 0
    v_mov_b32 v111, 0
    s_cmp_ge_u32 s27, 2
    s_cselect_b64 vcc, -1, 0
    v_cndmask_b32 v18, 0, v16, vcc
    v_cndmask_b32 v16, v16, 0, vcc
    v_cndmask_b32 v22, 0, v20, vcc
    v_cndmask_b32 v20, v20, 0, vcc
    v_cndmask_b32 v19, 0, v17, vcc
    v_cndmask_b32 v17, v17, 0, vcc
    v_cndmask_b32 v23, 0, v21, vcc
    v_cndmask_b32 v21, v21, 0, vcc
    v_cndmask_b32 v26, 0, v24, vcc
    v_cndmask_b32 v24, v24, 0, vcc
    v_cndmask_b32 v30, 0, v28, vcc
    v_cndmask_b32 v28, v28, 0, vcc
    v_cndmask_b32 v27, 0, v25, vcc
    v_cndmask_b32 v25, v25, 0, vcc
    v_cndmask_b32 v31, 0, v29, vcc
    v_cndmask_b32 v29, v29, 0, vcc
    v_cndmask_b32 v34, 0, v32, vcc
    v_cndmask_b32 v32, v32, 0, vcc
    v_cndmask_b32 v38, 0, v36, vcc
    v_cndmask_b32 v36, v36, 0, vcc
    v_cndmask_b32 v35, 0, v33, vcc
    v_cndmask_b32 v33, v33, 0, vcc
    v_cndmask_b32 v39, 0, v37, vcc
    v_cndmask_b32 v37, v37, 0, vcc
    v_cndmask_b32 v42, 0, v40, vcc
    v_cndmask_b32 v40, v40, 0, vcc
    v_cndmask_b32 v46, 0, v44, vcc
    v_cndmask_b32 v44, v44, 0, vcc
    v_cndmask_b32 v43, 0, v41, vcc
    v_cndmask_b32 v41, v41, 0, vcc
    v_cndmask_b32_e64 v47, 0, v45, vcc
    v_cndmask_b32 v45, v45, 0, vcc
skip_26:
    s_mov_b32 s52, 0x36000000
    s_waitcnt vmcnt(1)
    v_lshlrev_b32 v184, 16, v128
    v_and_b32 v185, 0xffff0000, v128
    v_lshlrev_b32 v186, 16, v129
    v_and_b32 v187, 0xffff0000, v129
    v_lshlrev_b32 v188, 16, v130
    v_and_b32 v189, 0xffff0000, v130
    v_lshlrev_b32 v190, 16, v131
    v_and_b32 v191, 0xffff0000, v131
    s_waitcnt vmcnt(0)
    v_lshlrev_b32 v192, 16, v132
    v_and_b32 v193, 0xffff0000, v132
    v_lshlrev_b32 v194, 16, v133
    v_and_b32 v195, 0xffff0000, v133
    v_lshlrev_b32 v196, 16, v134
    v_and_b32 v197, 0xffff0000, v134
    v_lshlrev_b32 v198, 16, v135
    v_and_b32 v199, 0xffff0000, v135
    v_mul_f32 v184, s52, v184
    v_mul_f32 v185, s52, v185
    v_mul_f32 v186, s52, v186
    v_mul_f32 v187, s52, v187
    v_mul_f32 v188, s52, v188
    v_mul_f32 v189, s52, v189
    v_mul_f32 v190, s52, v190
    v_mul_f32 v191, s52, v191
    v_mul_f32 v192, s52, v192
    v_mul_f32 v193, s52, v193
    v_mul_f32 v194, s52, v194
    v_mul_f32 v195, s52, v195
    v_mul_f32 v196, s52, v196
    v_mul_f32 v197, s52, v197
    v_mul_f32 v198, s52, v198
    v_mul_f32 v199, s52, v199
    s_waitcnt lgkmcnt(0)
spin_28:
    ds_read_b32 v200, v4 offset:76
    s_waitcnt lgkmcnt(0)
    v_readfirstlane_b32 s55, v200
    s_nop 0
    s_cmp_lt_u32 s55, 4
    s_cbranch_scc1 spin_28
    ds_read_b128 v[200:203], v12 offset:0
    ds_read_b128 v[204:207], v12 offset:1024
    ds_read_b128 v[208:211], v12 offset:2048
    ds_read_b128 v[212:215], v12 offset:3072
    ds_read_b128 v[216:219], v12 offset:4096
    ds_read_b128 v[220:223], v12 offset:5120
    ds_read_b128 v[224:227], v12 offset:6144
    ds_read_b128 v[228:231], v12 offset:7168
    s_waitcnt lgkmcnt(7)
    v_mfma_f32_16x16x32_bf16 v[232:235], v[200:203], v[16:19], 0
    v_mfma_f32_16x16x32_bf16 v[240:243], v[200:203], v[20:23], 0
    s_waitcnt lgkmcnt(6)
    v_mfma_f32_16x16x32_bf16 v[236:239], v[204:207], v[16:19], 0
    v_mfma_f32_16x16x32_bf16 v[244:247], v[204:207], v[20:23], 0
    s_waitcnt lgkmcnt(5)
    v_mfma_f32_16x16x32_bf16 v[232:235], v[208:211], v[24:27], v[232:235]
    v_mfma_f32_16x16x32_bf16 v[240:243], v[208:211], v[28:31], v[240:243]
    s_waitcnt lgkmcnt(4)
    v_mfma_f32_16x16x32_bf16 v[236:239], v[212:215], v[24:27], v[236:239]
    v_mfma_f32_16x16x32_bf16 v[244:247], v[212:215], v[28:31], v[244:247]
    s_waitcnt lgkmcnt(3)
    v_mfma_f32_16x16x32_bf16 v[232:235], v[216:219], v[32:35], v[232:235]
    v_mfma_f32_16x16x32_bf16 v[240:243], v[216:219], v[36:39], v[240:243]
    s_waitcnt lgkmcnt(2)
    v_mfma_f32_16x16x32_bf16 v[236:239], v[220:223], v[32:35], v[236:239]
    v_mfma_f32_16x16x32_bf16 v[244:247], v[220:223], v[36:39], v[244:247]
    s_waitcnt lgkmcnt(1)
    v_mfma_f32_16x16x32_bf16 v[232:235], v[224:227], v[40:43], v[232:235]
    v_mfma_f32_16x16x32_bf16 v[240:243], v[224:227], v[44:47], v[240:243]
    s_waitcnt lgkmcnt(0)
    v_mfma_f32_16x16x32_bf16 v[236:239], v[228:231], v[40:43], v[236:239]
    v_mfma_f32_16x16x32_bf16 v[244:247], v[228:231], v[44:47], v[244:247]
    s_nop 3
    v_cvt_pk_bf16_f32 v248, v232, v233
    v_cvt_pk_bf16_f32 v249, v234, v235
    s_nop 0
    v_cvt_pk_bf16_f32 v250, v236, v237
    v_cvt_pk_bf16_f32 v251, v238, v239
    v_cvt_pk_bf16_f32 v252, v240, v241
    v_cvt_pk_bf16_f32 v253, v242, v243
    v_cvt_pk_bf16_f32 v254, v244, v245
    v_cvt_pk_bf16_f32 v255, v246, v247
    s_cmp_eq_u32 s58, 0
    s_cbranch_scc1 special_29
    v_mfma_f32_16x16x32_bf16 v[200:203], v[48:51], v[248:251], 0
    v_mfma_f32_16x16x32_bf16 v[208:211], v[56:59], v[248:251], 0
    v_mfma_f32_16x16x32_bf16 v[204:207], v[60:63], v[248:251], 0
    v_mfma_f32_16x16x32_bf16 v[212:215], v[68:71], v[248:251], 0
    v_mfma_f32_16x16x32_bf16 v[200:203], v[52:55], v[252:255], v[200:203]
    v_mfma_f32_16x16x32_bf16 v[208:211], v[48:51], v[252:255], v[208:211]
    v_mfma_f32_16x16x32_bf16 v[204:207], v[64:67], v[252:255], v[204:207]
    v_mfma_f32_16x16x32_bf16 v[212:215], v[60:63], v[252:255], v[212:215]
    s_nop 4
    v_mul_f32 v216, v200, v184
    v_mul_f32 v224, v200, v185
    v_mul_f32 v217, v201, v186
    v_mul_f32 v225, v201, v187
    v_mul_f32 v218, v202, v188
    v_mul_f32 v226, v202, v189
    v_mul_f32 v219, v203, v190
    v_mul_f32 v227, v203, v191
    v_mul_f32 v220, v204, v192
    v_mul_f32 v228, v204, v193
    v_mul_f32 v221, v205, v194
    v_mul_f32 v229, v205, v195
    v_mul_f32 v222, v206, v196
    v_mul_f32 v230, v206, v197
    v_mul_f32 v223, v207, v198
    v_mul_f32 v231, v207, v199
    v_fma_f32 v216, -v208, v185, v216
    v_fmac_f32 v224, v208, v184
    v_fma_f32 v217, -v209, v187, v217
    v_fmac_f32 v225, v209, v186
    v_fma_f32 v218, -v210, v189, v218
    v_fmac_f32 v226, v210, v188
    v_fma_f32 v219, -v211, v191, v219
    v_fmac_f32 v227, v211, v190
    v_fma_f32 v220, -v212, v193, v220
    v_fmac_f32 v228, v212, v192
    v_fma_f32 v221, -v213, v195, v221
    v_fmac_f32 v229, v213, v194
    v_fma_f32 v222, -v214, v197, v222
    v_fmac_f32 v230, v214, v196
    v_fma_f32 v223, -v215, v199, v223
    v_fmac_f32_e64 v231, v215, v198
    v_cvt_pk_bf16_f32 v248, v216, v217
    v_cvt_pk_bf16_f32 v249, v218, v219
    v_cvt_pk_bf16_f32 v250, v220, v221
    v_cvt_pk_bf16_f32 v251, v222, v223
    v_cvt_pk_bf16_f32 v252, v224, v225
    v_cvt_pk_bf16_f32 v253, v226, v227
    v_cvt_pk_bf16_f32 v254, v228, v229
    v_cvt_pk_bf16_f32 v255, v230, v231
join_30:
    v_mfma_f32_16x16x32_bf16 v[232:235], v[248:251], v[72:75], 0
    v_mfma_f32_16x16x32_bf16 v[236:239], v[248:251], v[76:79], 0
    v_mfma_f32_16x16x32_bf16 v[240:243], v[248:251], v[84:87], 0
    v_mfma_f32_16x16x32_bf16 v[244:247], v[248:251], v[88:91], 0
    v_mfma_f32_16x16x32_bf16 v[232:235], v[252:255], v[80:83], v[232:235]
    v_mfma_f32_16x16x32_bf16 v[236:239], v[252:255], v[72:75], v[236:239]
    v_mfma_f32_16x16x32_bf16 v[240:243], v[252:255], v[92:95], v[240:243]
    v_mfma_f32_16x16x32_bf16 v[244:247], v[252:255], v[84:87], v[244:247]
    s_lshl_b32 s52, s27, 11
    v_add_u32_e64 v13, s52, v12
    s_nop 2
    v_cvt_pk_bf16_f32 v248, v232, v233
    v_cvt_pk_bf16_f32 v249, v234, v235
    v_cvt_pk_bf16_f32 v250, v236, v237
    v_cvt_pk_bf16_f32 v251, v238, v239
    v_cvt_pk_bf16_f32 v252, v240, v241
    v_cvt_pk_bf16_f32 v253, v242, v243
    v_cvt_pk_bf16_f32 v254, v244, v245
    v_cvt_pk_bf16_f32 v255, v246, v247
    ds_write_b128 v13, v[248:251] offset:8704
    ds_write_b128 v13, v[252:255] offset:9728
    s_waitcnt lgkmcnt(0)
    s_mov_b64 exec, 1
    ds_add_u32 v4, v5 offset:80
    s_mov_b64 exec, -1
    s_waitcnt lgkmcnt(0)
spin_31:
    ds_read_b32 v200, v4 offset:80
    s_waitcnt lgkmcnt(0)
    v_readfirstlane_b32 s55, v200
    s_nop 0
    s_cmp_lt_u32 s55, 4
    s_cbranch_scc1 spin_31
    ds_read_b128 v[200:203], v12 offset:8704
    ds_read_b128 v[204:207], v12 offset:9728
    ds_read_b128 v[208:211], v12 offset:10752
    ds_read_b128 v[212:215], v12 offset:11776
    ds_read_b128 v[216:219], v12 offset:12800
    ds_read_b128 v[220:223], v12 offset:13824
    ds_read_b128 v[224:227], v12 offset:14848
    ds_read_b128 v[228:231], v12 offset:15872
    s_waitcnt lgkmcnt(7)
    v_mfma_f32_16x16x32_bf16 v[232:235], v[96:99], v[200:203], 0
    v_mfma_f32_16x16x32_bf16 v[236:239], v[100:103], v[200:203], 0
    s_waitcnt lgkmcnt(6)
    v_mfma_f32_16x16x32_bf16 v[240:243], v[96:99], v[204:207], 0
    v_mfma_f32_16x16x32_bf16 v[244:247], v[100:103], v[204:207], 0
    s_waitcnt lgkmcnt(5)
    v_mfma_f32_16x16x32_bf16 v[232:235], v[104:107], v[208:211], v[232:235]
    v_mfma_f32_16x16x32_bf16 v[236:239], v[108:111], v[208:211], v[236:239]
    s_waitcnt lgkmcnt(4)
    v_mfma_f32_16x16x32_bf16 v[240:243], v[104:107], v[212:215], v[240:243]
    v_mfma_f32_16x16x32_bf16 v[244:247], v[108:111], v[212:215], v[244:247]
    s_waitcnt lgkmcnt(3)
    v_mfma_f32_16x16x32_bf16 v[232:235], v[112:115], v[216:219], v[232:235]
    v_mfma_f32_16x16x32_bf16 v[236:239], v[116:119], v[216:219], v[236:239]
    s_waitcnt lgkmcnt(2)
    v_mfma_f32_16x16x32_bf16 v[240:243], v[112:115], v[220:223], v[240:243]
    v_mfma_f32_16x16x32_bf16 v[244:247], v[116:119], v[220:223], v[244:247]
    s_waitcnt lgkmcnt(1)
    v_mfma_f32_16x16x32_bf16 v[232:235], v[120:123], v[224:227], v[232:235]
    v_mfma_f32_16x16x32_bf16 v[236:239], v[124:127], v[224:227], v[236:239]
    s_waitcnt lgkmcnt(0)
    v_mfma_f32_16x16x32_bf16 v[240:243], v[120:123], v[228:231], v[240:243]
    v_mfma_f32_16x16x32_bf16 v[244:247], v[124:127], v[228:231], v[244:247]
    s_nop 3
    v_cvt_pk_bf16_f32 v248, v232, v233
    v_cvt_pk_bf16_f32 v249, v234, v235
    v_cvt_pk_bf16_f32 v250, v236, v237
    v_cvt_pk_bf16_f32 v251, v238, v239
    v_cvt_pk_bf16_f32 v252, v240, v241
    v_cvt_pk_bf16_f32 v253, v242, v243
    v_cvt_pk_bf16_f32 v254, v244, v245
    v_cvt_pk_bf16_f32 v255, v246, v247
    v_and_b32 v248, -2, v248
    v_and_b32 v249, -2, v249
    v_and_b32 v250, -2, v250
    v_and_b32 v251, -2, v251
    v_and_b32 v252, -2, v252
    v_and_b32 v253, -2, v253
    v_and_b32 v254, -2, v254
    v_and_b32 v255, -2, v255
    buffer_store_dwordx4 v[248:251], v6, s[32:35], s70 offen sc1
    buffer_store_dwordx4 v[252:255], v6, s[32:35], s71 offen sc1
    v_add_f32 v200, 0.5, v15
    v_add_f32 v201, 4.0, v10
    v_mul_f32 v202, v15, v10
    v_mul_f32 v203, v15, v201
    v_mul_f32 v204, v200, v10
    v_mul_f32 v205, v200, v201
    v_cos_f32 v206, v202
    v_cos_f32 v207, v203
    v_cos_f32 v208, v204
    v_cos_f32 v209, v205
    v_sin_f32 v210, v202
    v_sin_f32 v211, v203
    v_sin_f32 v212, v204
    v_sin_f32 v213, v205
    v_cvt_pk_bf16_f32 v206, v206, v206
    v_cvt_pk_bf16_f32 v207, v207, v207
    v_cvt_pk_bf16_f32 v208, v208, v208
    v_cvt_pk_bf16_f32 v209, v209, v209
    v_cvt_pk_bf16_f32 v202, -v210, -v210
    v_cvt_pk_bf16_f32 v203, -v211, -v211
    v_cvt_pk_bf16_f32 v204, -v212, -v212
    v_cvt_pk_bf16_f32 v205, -v213, -v213
    v_cvt_pk_bf16_f32 v210, v210, v210
    v_cvt_pk_bf16_f32 v211, v211, v211
    v_cvt_pk_bf16_f32 v212, v212, v212
    v_cvt_pk_bf16_f32 v213, v213, v213
    v_and_b32 v130, v206, v7
    v_and_b32 v131, v206, v8
    v_and_b32 v132, v202, v7
    v_and_b32 v133, v202, v8
    v_and_b32 v128, v210, v7
    v_and_b32 v129, v210, v8
    v_and_b32 v136, v207, v7
    v_and_b32 v137, v207, v8
    v_and_b32 v138, v203, v7
    v_and_b32 v139, v203, v8
    v_and_b32 v134, v211, v7
    v_and_b32 v135, v211, v8
    v_and_b32 v142, v208, v7
    v_and_b32 v143, v208, v8
    v_and_b32 v144, v204, v7
    v_and_b32 v145, v204, v8
    v_and_b32 v140, v212, v7
    v_and_b32 v141, v212, v8
    v_and_b32 v148, v209, v7
    v_and_b32 v149, v209, v8
    v_and_b32 v150, v205, v7
    v_and_b32 v151, v205, v8
    v_and_b32 v146, v213, v7
    v_and_b32 v147, v213, v8
    v_cmp_eq_u32 vcc, 0, v3
    v_and_b32 v200, 7, v1
    s_lshl_b32 s52, s27, 3
    v_add_u32 v200, s52, v200
    v_cmp_eq_u32 s[62:63], 0, v200
    s_nop 0
    s_andn2_b64 s[64:65], s[62:63], vcc
    s_mov_b64 s[66:67], vcc
    v_lshrrev_b32 v200, 2, v200
    v_lshl_add_u32 v200, v200, 3, v3
    v_mul_u32_u24 v200, 32768, v200
    v_and_b32_e64 v201, 3, v1
    v_lshl_add_u32 v200, v201, 5, v200
    v_bfe_u32 v201, v1, 3, 1
    v_lshl_add_u32 v11, v201, 4, v200
    s_lshl_b32 s52, s58, 7
    s_add_u32 s72, s52, 1048576
    s_add_u32 s73, s72, 131072
    v_lshrrev_b32 v200, 1, v3
    v_lshlrev_b32 v200, 12, v200
    v_and_b32 v201, 1, v3
    v_lshl_add_u32 v200, v201, 8, v200
    v_lshl_add_u32 v200, v2, 4, v200
    s_lshl_b32 s53, s27, 9
    v_add_u32 v13, s53, v200
    v_add_f32 v200, 0x00000000, v9
    v_mul_f32 v200, 0x3c800000, v200
    v_mul_f32 v201, 4.0, v10
    v_mul_f32_e64 v201, v201, v200
    v_fmamk_f32 v203, v200, 0x3f800000, v201
    v_fmamk_f32 v204, v200, 0x40000000, v201
    v_fmamk_f32 v205, v200, 0x40400000, v201
    v_cos_f32 v206, v201
    v_cos_f32 v207, v203
    v_cos_f32 v208, v204
    v_cos_f32 v209, v205
    v_sin_f32 v210, v201
    v_sin_f32 v211, v203
    v_sin_f32 v212, v204
    v_sin_f32 v213, v205
    v_cvt_pk_bf16_f32 v152, v206, v207
    v_cvt_pk_bf16_f32 v153, v208, v209
    v_cvt_pk_bf16_f32 v154, -v210, -v211
    v_cvt_pk_bf16_f32 v155, -v212, -v213
    v_fmamk_f32 v202, v200, 0x41800000, v201
    v_fmamk_f32 v203, v200, 0x41880000, v201
    v_fmamk_f32 v204, v200, 0x41900000, v201
    v_fmamk_f32 v205, v200, 0x41980000, v201
    v_cos_f32 v206, v202
    v_cos_f32 v207, v203
    v_cos_f32 v208, v204
    v_cos_f32 v209, v205
    v_sin_f32 v210, v202
    v_sin_f32 v211, v203
    v_sin_f32 v212, v204
    v_sin_f32 v213, v205
    v_cvt_pk_bf16_f32 v156, v206, v207
    v_cvt_pk_bf16_f32 v157, v208, v209
    v_cvt_pk_bf16_f32 v158, -v210, -v211
    v_cvt_pk_bf16_f32 v159, -v212, -v213
    v_add_f32 v200, 0x41800000, v9
    v_mul_f32 v200, 0x3c800000, v200
    v_mul_f32 v201, 4.0, v10
    v_mul_f32 v201, v201, v200
    v_fmamk_f32 v203, v200, 0x3f800000, v201
    v_fmamk_f32 v204, v200, 0x40000000, v201
    v_fmamk_f32 v205, v200, 0x40400000, v201
    v_cos_f32 v206, v201
    v_cos_f32 v207, v203
    v_cos_f32 v208, v204
    v_cos_f32 v209, v205
    v_sin_f32 v210, v201
    v_sin_f32 v211, v203
    v_sin_f32 v212, v204
    v_sin_f32 v213, v205
    v_cvt_pk_bf16_f32 v160, v206, v207
    v_cvt_pk_bf16_f32 v161, v208, v209
    v_cvt_pk_bf16_f32 v162, -v210, -v211
    v_cvt_pk_bf16_f32 v163, -v212, -v213
    v_fmamk_f32 v202, v200, 0x41800000, v201
    v_fmamk_f32 v203, v200, 0x41880000, v201
    v_fmamk_f32 v204, v200, 0x41900000, v201
    v_fmamk_f32 v205, v200, 0x41980000, v201
    v_cos_f32 v206, v202
    v_cos_f32 v207, v203
    v_cos_f32 v208, v204
    v_cos_f32 v209, v205
    v_sin_f32 v210, v202
    v_sin_f32 v211, v203
    v_sin_f32 v212, v204
    v_sin_f32 v213, v205
    v_cvt_pk_bf16_f32 v164, v206, v207
    v_cvt_pk_bf16_f32 v165, v208, v209
    v_cvt_pk_bf16_f32 v166, -v210, -v211
    v_cvt_pk_bf16_f32 v167, -v212, -v213
    s_waitcnt vmcnt(0)
    v_add_f32 v200, 0x42000000, v9
    v_mul_f32 v200, 0x3c800000, v200
    v_mul_f32 v201, 4.0, v10
    v_mul_f32_e64 v201, v201, v200
    v_fmamk_f32 v203, v200, 0x3f800000, v201
    v_fmamk_f32 v204, v200, 0x40000000, v201
    v_fmamk_f32 v205, v200, 0x40400000, v201
    v_cos_f32 v206, v201
    v_cos_f32 v207, v203
    v_cos_f32 v208, v204
    v_cos_f32 v209, v205
    v_sin_f32 v210, v201
    v_sin_f32 v211, v203
    v_sin_f32 v212, v204
    v_sin_f32 v213, v205
    v_cvt_pk_bf16_f32 v168, v206, v207
    v_cvt_pk_bf16_f32 v169, v208, v209
    v_cvt_pk_bf16_f32 v170, -v210, -v211
    v_cvt_pk_bf16_f32 v171, -v212, -v213
    v_fmamk_f32 v202, v200, 0x41800000, v201
    v_fmamk_f32 v203, v200, 0x41880000, v201
    v_fmamk_f32 v204, v200, 0x41900000, v201
    v_fmamk_f32 v205, v200, 0x41980000, v201
    v_cos_f32 v206, v202
    v_cos_f32 v207, v203
    v_cos_f32 v208, v204
    v_cos_f32 v209, v205
    v_sin_f32 v210, v202
    v_sin_f32 v211, v203
    v_sin_f32 v212, v204
    v_sin_f32 v213, v205
    v_cvt_pk_bf16_f32 v172, v206, v207
    v_cvt_pk_bf16_f32 v173, v208, v209
    v_cvt_pk_bf16_f32 v174, -v210, -v211
    v_cvt_pk_bf16_f32 v175, -v212, -v213
    v_add_f32 v200, 0x42400000, v9
    v_mul_f32 v200, 0x3c800000, v200
    v_mul_f32 v201, 4.0, v10
    v_mul_f32 v201, v201, v200
    v_fmamk_f32 v203, v200, 0x3f800000, v201
    v_fmamk_f32 v204, v200, 0x40000000, v201
    v_fmamk_f32 v205, v200, 0x40400000, v201
    v_cos_f32 v206, v201
    v_cos_f32 v207, v203
    v_cos_f32 v208, v204
    v_cos_f32 v209, v205
    v_sin_f32 v210, v201
    v_sin_f32 v211, v203
    v_sin_f32 v212, v204
    v_sin_f32 v213, v205
    v_cvt_pk_bf16_f32 v176, v206, v207
    v_cvt_pk_bf16_f32 v177, v208, v209
    v_cvt_pk_bf16_f32 v178, -v210, -v211
    v_cvt_pk_bf16_f32 v179, -v212, -v213
    v_fmamk_f32 v202, v200, 0x41800000, v201
    v_fmamk_f32 v203, v200, 0x41880000, v201
    v_fmamk_f32 v204, v200, 0x41900000, v201
    v_fmamk_f32 v205, v200, 0x41980000, v201
    v_cos_f32 v206, v202
    v_cos_f32 v207, v203
    v_cos_f32 v208, v204
    v_cos_f32 v209, v205
    v_sin_f32 v210, v202
    v_sin_f32 v211, v203
    v_sin_f32 v212, v204
    v_sin_f32 v213, v205
    v_cvt_pk_bf16_f32 v180, v206, v207
    v_cvt_pk_bf16_f32 v181, v208, v209
    v_cvt_pk_bf16_f32 v182, -v210, -v211
    v_cvt_pk_bf16_f32 v183, -v212, -v213
    v_mov_b32 v202, 0xffff
    v_and_b32 v200, 1, v2
    v_lshlrev_b32 v200, 15, v200
    v_or_b32 v200, 0x3f80, v200
    v_bfi_b32 v201, v202, v200, v154
    v_cndmask_b32 v154, v154, v201, s[66:67]
    v_bfi_b32 v201, v202, v200, v162
    v_cndmask_b32 v162, v162, v201, s[66:67]
    v_bfi_b32 v201, v202, v200, v170
    v_cndmask_b32 v170, v170, v201, s[66:67]
    v_bfi_b32 v201, v202, v200, v178
    v_cndmask_b32 v178, v178, v201, s[66:67]
    s_branch spin_33
spin4_32:
    s_sleep 1
spin_33:
    ds_read_b32 v200, v4 offset:32
    s_waitcnt lgkmcnt(0)
    v_cmp_ne_u32 vcc, 16843009, v200
    s_cbranch_vccnz spin4_32
    buffer_load_dwordx4 v[184:187], v11, s[32:35], s72 offen sc1
    buffer_load_dwordx4 v[188:191], v11, s[32:35], s73 offen sc1
    s_mov_b32 s53, 0
    s_waitcnt vmcnt(0)
e2poll_34:
    v_or3_b32 v208, v184, v185, v186
    v_or3_b32 v209, v187, v188, v189
    v_or3_b32 v208, v208, v190, v191
    v_or_b32 v208, v208, v209
    v_and_b32 v208, 1, v208
    v_cmp_ne_u32_e64 vcc, 0, v208
    s_cbranch_vccz e2ok_35
    buffer_load_dwordx4 v[184:187], v11, s[32:35], s72 offen sc1
    buffer_load_dwordx4 v[188:191], v11, s[32:35], s73 offen sc1
    s_waitcnt vmcnt(0)
    s_add_u32 s53, s53, 1
    s_cmp_lt_u32 s53, 200000
    s_cbranch_scc1 e2poll_34
e2ok_35:
    v_cndmask_b32 v208, v184, 0, s[64:65]
    v_cndmask_b32 v212, v188, 0, s[64:65]
    v_cndmask_b32 v209, v185, 0, s[64:65]
    v_cndmask_b32 v213, v189, 0, s[64:65]
    v_cndmask_b32 v210, v186, 0, s[64:65]
    v_cndmask_b32 v214, v190, 0, s[64:65]
    v_cndmask_b32 v211, v187, 0, s[64:65]
    v_cndmask_b32 v215, v191, 0, s[64:65]
    v_mfma_f32_16x16x32_bf16 v[232:235], v[184:187], v[130:133], 0
    v_mfma_f32_16x16x32_bf16 v[236:239], v[188:191], v[134:137], 0
    v_mfma_f32_16x16x32_bf16 v[240:243], v[184:187], v[142:145], 0
    v_mfma_f32_16x16x32_bf16 v[244:247], v[188:191], v[146:149], 0
    v_mfma_f32_16x16x32_bf16 v[232:235], v[212:215], v[136:139], v[232:235]
    v_mfma_f32_16x16x32_bf16 v[236:239], v[208:211], v[128:131], v[236:239]
    v_mfma_f32_16x16x32_bf16 v[240:243], v[212:215], v[148:151], v[240:243]
    v_mfma_f32_16x16x32_bf16 v[244:247], v[208:211], v[140:143], v[244:247]
    s_nop 4
    s_nop 0
    v_cvt_pk_bf16_f32 v248, v232, v233
    v_cvt_pk_bf16_f32 v249, v234, v235
    v_cvt_pk_bf16_f32 v250, v236, v237
    v_cvt_pk_bf16_f32 v251, v238, v239
    v_cvt_pk_bf16_f32 v252, v240, v241
    v_cvt_pk_bf16_f32 v253, v242, v243
    v_cvt_pk_bf16_f32 v254, v244, v245
    v_cvt_pk_bf16_f32 v255, v246, v247
    ds_write_b128 v13, v[248:251] offset:0
    ds_write_b128 v13, v[252:255] offset:2048
    s_waitcnt lgkmcnt(0)
    s_mov_b64 exec, 1
    ds_add_u32 v4, v5 offset:84
    s_mov_b64 exec, -1
    s_and_b32 s52, s27, 1
    s_lshl_b32 s52, s52, 12
    s_lshr_b32 s53, s27, 1
    s_lshl_b32 s54, s53, 11
    s_add_u32 s52, s52, s54
    v_add_u32 v13, s52, v12
    s_lshl_b32 s53, s53, 2
    v_add_u32 v209, s53, v3
    v_and_b32 v210, 7, v2
    v_xor_b32 v209, v209, v210
    v_lshlrev_b32 v209, 5, v209
    v_lshl_add_u32 v209, v2, 8, v209
    s_and_b32 s52, s27, 1
    s_lshl_b32 s52, s52, 4
    v_add_u32_e64 v11, s52, v209
    v_lshlrev_b32 v210, 2, v2
    ds_read_b32 v212, v210 offset:17920
    ds_read_b32 v213, v210 offset:17984
    ds_read_b32 v214, v210 offset:18048
    ds_read_b32 v215, v210 offset:18112
    s_waitcnt lgkmcnt(0)
spin_36:
    ds_read_b32 v208, v4 offset:84
    s_waitcnt lgkmcnt(0)
    v_readfirstlane_b32 s55, v208
    s_nop 0
    s_cmp_lt_u32 s55, 4
    s_cbranch_scc1 spin_36
    ds_read_b128 v[200:203], v13 offset:0
    ds_read_b128 v[204:207], v13 offset:1024
    s_waitcnt lgkmcnt(0)
    s_mov_b64 exec, 1
    ds_add_u32 v4, v5 offset:100
    s_mov_b64 exec, -1
    v_mfma_f32_16x16x32_bf16 v[232:235], v[200:203], v[152:155], 0
    v_mfma_f32_16x16x32_bf16 v[236:239], v[200:203], v[160:163], 0
    v_mfma_f32_16x16x32_bf16 v[240:243], v[200:203], v[168:171], 0
    v_mfma_f32_16x16x32_bf16 v[244:247], v[200:203], v[176:179], 0
    v_mfma_f32_16x16x32_bf16 v[232:235], v[204:207], v[156:159], v[232:235]
    v_mfma_f32_16x16x32_bf16 v[236:239], v[204:207], v[164:167], v[236:239]
    v_mfma_f32_16x16x32_bf16 v[240:243], v[204:207], v[172:175], v[240:243]
    v_mfma_f32_16x16x32_bf16 v[244:247], v[204:207], v[180:183], v[244:247]
    s_waitcnt lgkmcnt(0)
spin_37:
    ds_read_b32 v208, v4 offset:100
    s_waitcnt lgkmcnt(0)
    v_readfirstlane_b32 s55, v208
    s_nop 0
    s_cmp_lt_u32 s55, 4
    s_cbranch_scc1 spin_37
    v_mul_f32 v232, v212, v232
    v_mul_f32 v233, v212, v233
    v_mul_f32 v234, v212, v234
    v_mul_f32 v235, v212, v235
    ds_write_b128 v11, v[232:235] offset:0
    v_mul_f32 v236, v213, v236
    v_mul_f32 v237, v213, v237
    v_mul_f32 v238, v213, v238
    v_mul_f32 v239, v213, v239
    ds_write_b128 v11, v[236:239] offset:4096
    v_mul_f32 v240, v214, v240
    v_mul_f32 v241, v214, v241
    v_mul_f32 v242, v214, v242
    v_mul_f32 v243, v214, v243
    ds_write_b128 v11, v[240:243] offset:8192
    v_mul_f32 v244, v215, v244
    v_mul_f32 v245, v215, v245
    v_mul_f32 v246, v215, v246
    v_mul_f32 v247, v215, v247
    ds_write_b128 v11, v[244:247] offset:12288
    s_mul_i32 s52, s27, 12288
    s_add_u32 s52, s52, 84864
    v_add_u32 v2, s52, v12
    v_and_b32 v10, 31, v1
    s_and_b32 s52, s27, 1
    s_lshl_b32 s52, s52, 5
    v_add_u32 v10, s52, v10
    v_lshrrev_b32 v11, 5, v1
    s_lshr_b32 s52, s27, 1
    s_lshl_b32 s52, s52, 2
    v_add_u32 v11, s52, v11
    v_lshlrev_b32 v8, 2, v10
    v_and_b32 v13, 7, v10
    v_xor_b32 v13, v13, v11
    v_lshlrev_b32 v3, 8, v10
    v_lshl_add_u32 v3, v13, 5, v3
    v_xor_b32 v13, 64, v3
    v_lshlrev_b32 v9, 15, v10
    v_lshl_add_u32 v9, v11, 7, v9
    s_lshl_b32 s101, s24, 10
    s_lshl_b32 s52, s25, 4
    s_add_u32 s101, s101, s52
    s_lshl_b32 s52, s27, 11
    s_add_u32 s52, s52, 134016
    v_add_u32 v10, s52, v12
    s_mov_b32 s48, s20
    s_mov_b32 s49, s21
    s_mov_b32 s50, 2097152
    s_mov_b32 s51, 0x20000
    s_waitcnt lgkmcnt(0)
L_FQ:
    s_or_b32 s52, s2, s27
    s_cmp_eq_u32 s52, 0
    s_cselect_b32 s52, 0, 1073741824
    v_mov_b32 v200, s56
    v_mov_b32 v201, s57
    v_mov_b32 v202, 0
    s_mov_b64 exec, 1
    buffer_store_dwordx2 v[200:201], v202, s[32:35], s52 offen
    s_mov_b64 exec, -1
    s_barrier
    ds_read_b32 v14, v8 offset:17920
    ds_read_b128 v[100:103], v10 offset:0
    ds_read_b128 v[104:107], v10 offset:1024
    ds_read_b128 v[20:23], v2 offset:1024
    ds_read_b128 v[28:31], v2 offset:3072
    ds_read_b128 v[36:39], v2 offset:5120
    ds_read_b128 v[44:47], v2 offset:7168
    ds_read_b128 v[52:55], v2 offset:9216
    ds_read_b128 v[60:63], v2 offset:11264
    ds_read_b128 v[72:75], v13 offset:0
    ds_read_b128 v[76:79], v13 offset:16
    s_waitcnt lgkmcnt(10)
    v_sub_f32 v14, 1.0, v14
    s_waitcnt lgkmcnt(7)
    v_pk_add_f32 v[100:101], v[100:101], v[20:21]
    v_pk_add_f32 v[102:103], v[102:103], v[22:23]
    s_waitcnt lgkmcnt(6)
    v_pk_add_f32 v[104:105], v[104:105], v[28:29]
    v_pk_add_f32 v[106:107], v[106:107], v[30:31]
    s_waitcnt lgkmcnt(5)
    v_pk_add_f32 v[100:101], v[100:101], v[36:37]
    v_pk_add_f32 v[102:103], v[102:103], v[38:39]
    s_waitcnt lgkmcnt(4)
    v_pk_add_f32 v[104:105], v[104:105], v[44:45]
    v_pk_add_f32 v[106:107], v[106:107], v[46:47]
    s_waitcnt lgkmcnt(3)
    v_pk_add_f32 v[100:101], v[100:101], v[52:53]
    v_pk_add_f32 v[102:103], v[102:103], v[54:55]
    s_waitcnt lgkmcnt(2)
    v_pk_add_f32 v[104:105], v[104:105], v[60:61]
    v_pk_add_f32 v[106:107], v[106:107], v[62:63]
    s_waitcnt lgkmcnt(1)
    v_fmac_f32 v72, v14, v100
    v_fmac_f32 v73, v14, v104
    v_fmac_f32 v74, v14, v101
    v_fmac_f32 v75, v14, v105
    s_waitcnt lgkmcnt(0)
    v_fmac_f32 v76, v14, v102
    v_fmac_f32 v77, v14, v106
    v_fmac_f32_e64 v78, v14, v103
    v_fmac_f32 v79, v14, v107
    v_cvt_pk_bf16_f32 v84, v72, v73
    v_cvt_pk_bf16_f32 v85, v74, v75
    v_cvt_pk_bf16_f32 v86, v76, v77
    v_cvt_pk_bf16_f32 v87, v78, v79
    buffer_store_dwordx4 v[84:87], v9, s[48:51], s101 offen offset:256
    s_endpgm
special_29:
    v_mfma_f32_16x16x32_bf16 v[200:203], v[48:51], v[248:251], 0
    v_mfma_f32_16x16x32_bf16 v[208:211], v[56:59], v[248:251], 0
    v_mfma_f32_16x16x32_bf16 v[216:219], v[52:55], v[252:255], 0
    v_mfma_f32_16x16x32_bf16 v[224:227], v[48:51], v[252:255], 0
    v_mfma_f32_16x16x32_bf16 v[204:207], v[60:63], v[248:251], 0
    v_mfma_f32_16x16x32_bf16 v[212:215], v[68:71], v[248:251], 0
    v_mfma_f32_16x16x32_bf16 v[220:223], v[64:67], v[252:255], 0
    v_mfma_f32_16x16x32_bf16 v[228:231], v[60:63], v[252:255], 0
    s_waitcnt vmcnt(0)
    s_mov_b32 s52, 0x36000000
    v_lshlrev_b32 v152, 16, v168
    v_and_b32 v153, 0xffff0000, v168
    v_lshlrev_b32 v154, 16, v169
    v_and_b32 v155, 0xffff0000, v169
    v_lshlrev_b32 v156, 16, v170
    v_and_b32 v157, 0xffff0000, v170
    v_lshlrev_b32 v158, 16, v171
    v_and_b32 v159, 0xffff0000, v171
    v_lshlrev_b32 v160, 16, v172
    v_and_b32 v161, 0xffff0000, v172
    v_lshlrev_b32 v162, 16, v173
    v_and_b32 v163, 0xffff0000, v173
    v_lshlrev_b32 v164, 16, v174
    v_and_b32 v165, 0xffff0000, v174
    v_lshlrev_b32 v166, 16, v175
    v_and_b32 v167, 0xffff0000, v175
    v_mul_f32 v152, s52, v152
    v_mul_f32 v153, s52, v153
    v_mul_f32 v154, s52, v154
    v_mul_f32 v155, s52, v155
    v_mul_f32 v156, s52, v156
    v_mul_f32 v157, s52, v157
    v_mul_f32 v158, s52, v158
    v_mul_f32 v159, s52, v159
    v_mul_f32 v160, s52, v160
    v_mul_f32 v161, s52, v161
    v_mul_f32 v162, s52, v162
    v_mul_f32 v163, s52, v163
    v_mul_f32 v164, s52, v164
    v_mul_f32 v165, s52, v165
    v_mul_f32 v166, s52, v166
    v_mul_f32 v167, s52, v167
    s_and_b32 s52, s27, 1
    v_or_b32 v232, s52, v2
    v_cmp_eq_u32 vcc, 0, v232
    s_nop 1
    v_cndmask_b32 v152, v184, v152, vcc
    v_cndmask_b32 v153, v185, v153, vcc
    v_cndmask_b32 v154, v186, v154, vcc
    v_cndmask_b32 v155, v187, v155, vcc
    v_cndmask_b32 v156, v188, v156, vcc
    v_cndmask_b32 v157, v189, v157, vcc
    v_cndmask_b32 v158, v190, v158, vcc
    v_cndmask_b32 v159, v191, v159, vcc
    v_cndmask_b32 v160, v192, v160, vcc
    v_cndmask_b32 v161, v193, v161, vcc
    v_cndmask_b32 v162, v194, v162, vcc
    v_cndmask_b32 v163, v195, v163, vcc
    v_cndmask_b32 v164, v196, v164, vcc
    v_cndmask_b32 v165, v197, v165, vcc
    v_cndmask_b32 v166, v198, v166, vcc
    v_cndmask_b32 v167, v199, v167, vcc
    v_mul_f32 v232, v200, v184
    v_mul_f32 v233, v200, v185
    v_fma_f32 v232, -v208, v185, v232
    v_fmac_f32 v233, v208, v184
    v_fma_f32 v232, -v224, v153, v232
    v_fmac_f32_e64 v233, v224, v152
    v_fma_f32 v200, v216, v152, v232
    v_fma_f32 v208, v216, v153, v233
    v_mul_f32 v234, v201, v186
    v_mul_f32 v235, v201, v187
    v_fma_f32 v234, -v209, v187, v234
    v_fmac_f32 v235, v209, v186
    v_fma_f32 v234, -v225, v155, v234
    v_fmac_f32 v235, v225, v154
    v_fma_f32 v201, v217, v154, v234
    v_fma_f32 v209, v217, v155, v235
    v_mul_f32 v232, v202, v188
    v_mul_f32 v233, v202, v189
    v_fma_f32 v232, -v210, v189, v232
    v_fmac_f32 v233, v210, v188
    v_fma_f32 v232, -v226, v157, v232
    v_fmac_f32 v233, v226, v156
    v_fma_f32 v202, v218, v156, v232
    v_fma_f32 v210, v218, v157, v233
    v_mul_f32 v234, v203, v190
    v_mul_f32 v235, v203, v191
    v_fma_f32 v234, -v211, v191, v234
    v_fmac_f32 v235, v211, v190
    v_fma_f32 v234, -v227, v159, v234
    v_fmac_f32 v235, v227, v158
    v_fma_f32 v203, v219, v158, v234
    v_fma_f32 v211, v219, v159, v235
    v_mul_f32 v232, v204, v192
    v_mul_f32 v233, v204, v193
    v_fma_f32 v232, -v212, v193, v232
    v_fmac_f32 v233, v212, v192
    v_fma_f32 v232, -v228, v161, v232
    v_fmac_f32 v233, v228, v160
    v_fma_f32 v204, v220, v160, v232
    v_fma_f32 v212, v220, v161, v233
    v_mul_f32 v234, v205, v194
    v_mul_f32 v235, v205, v195
    v_fma_f32 v234, -v213, v195, v234
    v_fmac_f32 v235, v213, v194
    v_fma_f32 v234, -v229, v163, v234
    v_fmac_f32 v235, v229, v162
    v_fma_f32 v205, v221, v162, v234
    v_fma_f32 v213, v221, v163, v235
    v_mul_f32 v232, v206, v196
    v_mul_f32 v233, v206, v197
    v_fma_f32 v232, -v214, v197, v232
    v_fmac_f32 v233, v214, v196
    v_fma_f32 v232, -v230, v165, v232
    v_fmac_f32 v233, v230, v164
    v_fma_f32 v206, v222, v164, v232
    v_fma_f32 v214, v222, v165, v233
    v_mul_f32 v234, v207, v198
    v_mul_f32 v235, v207, v199
    v_fma_f32 v234, -v215, v199, v234
    v_fmac_f32 v235, v215, v198
    v_fma_f32 v234, -v231, v167, v234
    v_fmac_f32 v235, v231, v166
    v_fma_f32 v207, v223, v166, v234
    v_fma_f32 v215, v223, v167, v235
    v_cvt_pk_bf16_f32 v248, v200, v201
    v_cvt_pk_bf16_f32 v249, v202, v203
    v_cvt_pk_bf16_f32 v250, v204, v205
    v_cvt_pk_bf16_f32 v251, v206, v207
    v_cvt_pk_bf16_f32 v252, v208, v209
    v_cvt_pk_bf16_f32 v253, v210, v211
    v_cvt_pk_bf16_f32 v254, v212, v213
    v_cvt_pk_bf16_f32 v255, v214, v215
    s_nop 1
    s_branch join_30
L_END:
    s_endpgm
.section .rodata,"a"
.p2align 6
.amdhsa_kernel gated_mix__spectral_gfnet__dense_activation_mish__prompt_kernel
  .amdhsa_next_free_vgpr 256
  .amdhsa_next_free_sgpr 102
  .amdhsa_accum_offset 256
  .amdhsa_group_segment_fixed_size 0
  .amdhsa_kernarg_size 88
  .amdhsa_user_sgpr_count 2
  .amdhsa_user_sgpr_kernarg_segment_ptr 1
  .amdhsa_system_sgpr_workgroup_id_x 1
  .amdhsa_float_denorm_mode_32 3
.end_amdhsa_kernel
```
